```python
import torch

def _softmax(x, axis=-1):
    return torch.softmax(x, dim=axis)
def _gelu(x):
    return torch.nn.functional.gelu(x, approximate="tanh")
def _silu(x):
    return torch.nn.functional.silu(x)
def _sigmoid(x):
    return torch.sigmoid(x)
def _layernorm(x, axis=-1, eps=1e-5):
    m = x.mean(dim=axis, keepdim=True)
    v = x.var(dim=axis, keepdim=True, unbiased=False)
    return (x - m) / torch.sqrt(v + eps)
def _scatter_add(tgt, idx, src, axis=0):
    return tgt.clone().index_add_(axis, idx, src)
def _segment_sum(src, seg, n):
    out = torch.zeros((n,) + src.shape[1:], dtype=src.dtype)
    return out.index_add_(0, seg, src)
def _pad(x, pw):
    flat = tuple(v for pair in reversed(pw) for v in pair)
    return torch.nn.functional.pad(x, flat)

kernel_name = 'interleave_layers__ssm_conv_h3__dense_activation_relu__prompt'

def setup_inputs():

    _w = (lambda a: (lambda t: t.to(torch.bfloat16) if t.is_floating_point() else t)(torch.as_tensor(a)))
    def _A_setup():
        B, S, D = 1, 2048, 512
        ks = 4
        return {
            "q": _w((lambda *s: torch.randn(*s, dtype=torch.bfloat16) * 0.05)(B, S, D)),
            "k": _w((lambda *s: torch.randn(*s, dtype=torch.bfloat16) * 0.8)(B, S, D)),
            "v": _w((lambda *s: torch.randn(*s, dtype=torch.bfloat16) * 0.8)(B, S, D)),
            "shift_k": _w((lambda *s: torch.randn(*s, dtype=torch.bfloat16) * 0.8)(D, ks) * 0.5),
            "ssm_k": _w((lambda *s: torch.randn(*s, dtype=torch.bfloat16) * 0.8)(D, S) * (1.0 / S ** 0.5)),
            "ssm_D": _w((lambda *s: torch.randn(*s, dtype=torch.bfloat16) * 0.8)(D)),
        }
    _A_in = _A_setup()

    def _B_setup():
        B, S, D, Dff = 1, 2048, 512, 1376
        return {
            "x": _w((lambda *s: torch.randn(*s, dtype=torch.bfloat16) * 0.05)(B, S, D)),
            "w1": _w((lambda *s: torch.randn(*s, dtype=torch.bfloat16) * 0.1)(D, Dff)),
            "w2": _w((lambda *s: torch.randn(*s, dtype=torch.bfloat16) * 0.1)(Dff, D)),
        }
    _B_in = _B_setup()

    return {
        "A_q": _A_in["q"],
        "A_k": _A_in["k"],
        "A_v": _A_in["v"],
        "A_shift_k": _A_in["shift_k"],
        "A_ssm_k": _A_in["ssm_k"],
        "A_ssm_D": _A_in["ssm_D"],
        "B_x": _B_in["x"],
        "B_w1": _B_in["w1"],
        "B_w2": _B_in["w2"],
    }

def reference(A_q, A_k, A_v, A_shift_k, A_ssm_k, A_ssm_D, B_x, B_w1, B_w2):
    def _A_ref(q, k, v, shift_k, ssm_k, ssm_D):
        B, S, D = q.shape
        ks = shift_k.shape[-1]
        k_pad = _pad(k, ((0, 0), (ks - 1, 0), (0, 0)))
        k_shift = torch.zeros_like(k)
        for t in range(ks):
            k_shift = k_shift + k_pad[:, t:t + S, :] * shift_k[:, ks - 1 - t][None, None, :]
        kv = k_shift * v
        L = 2 * S
        kv_pad = _pad(kv, ((0, 0), (0, S), (0, 0)))
        kf_pad = _pad(ssm_k, ((0, 0), (0, S)))
        kv_f = (lambda x, axes=(-2,-1): torch.fft.rfft2(x.float(), dim=axes))(kv_pad[:, None, :, :], axes=(1, 2))
        kf_f = (lambda x, axes=(-2,-1): torch.fft.rfft2(x.float(), dim=axes))(kf_pad[:, None, :], axes=(1, 2))
        kf_f = (lambda x, *d: x.permute(*d))(kf_f, 1, 2, 0)
        y_f = kv_f * kf_f[None, :, :, :]
        y = (lambda x, s, axes=(-2,-1): torch.fft.irfft2(x, s=s, dim=axes).to(torch.bfloat16))(y_f, (1, L), axes=(1, 2))[:, 0, :S, :]
        y = y + kv * ssm_D[None, None, :]
        return q * y

    def _B_ref(x, w1, w2):
        h = torch.einsum("bsd,df->bsf", x, w1)
        zero = torch.zeros_like(h)
        h = torch.maximum(h, zero)
        return torch.einsum("bsf,fd->bsd", h, w2)

    x = A_q
    x = x + _A_ref(_layernorm(x, axis=-1), A_k, A_v, A_shift_k, A_ssm_k, A_ssm_D)
    x = x + _B_ref(_layernorm(x, axis=-1), B_w1, B_w2)
    x = x + _A_ref(_layernorm(x, axis=-1), A_k, A_v, A_shift_k, A_ssm_k, A_ssm_D)
    x = x + _B_ref(_layernorm(x, axis=-1), B_w1, B_w2)
    return x
```

```asm
; @launch grid=(256,1,1) block=(512,1,1) lds=163840
.amdgcn_target "amdgcn-amd-amdhsa--gfx950"
.text
.globl interleave_layers__ssm_conv_h3__dense_activation_relu__prompt_kernel
.p2align 8
.type interleave_layers__ssm_conv_h3__dense_activation_relu__prompt_kernel,@function
interleave_layers__ssm_conv_h3__dense_activation_relu__prompt_kernel:
  s_cmp_ge_u32 s2, 256
  s_cbranch_scc1 L_END
  s_load_dwordx16 s[16:31], s[0:1], 0
  s_load_dwordx8 s[32:39], s[0:1], 64
  s_getpc_b64 s[12:13]
L_PC:
  v_lshrrev_b32 v1, 6, v0
  v_and_b32 v0, 63, v0
  v_readfirstlane_b32 s3, v1
  s_and_b32 s4, s2, 7
  s_lshr_b32 s5, s2, 3
  v_and_b32 v1, 15, v0
  v_lshrrev_b32 v2, 4, v0
  s_mov_b32 s10, 0
  s_and_b32 s15, s3, 3
  s_lshl_b32 s8, s4, 5
  s_add_u32 s8, s8, s5
  s_cmp_lt_u32 s3, 4
  s_cbranch_scc1 L_G2
  v_lshlrev_b32 v7, 4, v0
  s_cmp_lg_u32 s15, 0
  s_cbranch_scc1 L_NOPF
  s_lshl_b32 s11, s5, 11
  v_lshl_add_u32 v3, v1, 7, s11
  v_min_u32 v3, L_CODE_END-L_PC-4, v3
  global_load_dword v255, v3, s[12:13]
  v_cmp_gt_u32 vcc, 8, v0
  v_mov_b32 v6, 0
  s_nop 0
  v_cndmask_b32 v12, -1, v6, vcc
  v_mov_b32 v13, v12
  v_mov_b32 v14, v12
  v_mov_b32 v15, v12
  v_add_u32 v16, 157696, v7
  ds_write_b128 v16, v[12:15]
L_NOPF:
  s_lshr_b32 s13, s15, 1
  s_lshl_b32 s12, s8, 1
  s_add_u32 s12, s12, s13
  s_lshl_b32 s12, s12, 12
  s_and_b32 s14, s15, 1
  s_lshl_b32 s11, s14, 1
  s_add_u32 s12, s12, s11
  s_mul_i32 s13, s13, 8320
  s_add_u32 s67, s13, 65536
  s_mul_i32 s14, s14, 4160
  s_add_u32 s13, s13, s14
  s_add_u32 m0, s13, 65568
  s_waitcnt lgkmcnt(0)
  s_load_dword s9, s[38:39], 0
  s_mov_b32 s52, s24
  s_mov_b32 s53, s25
  s_mov_b32 s54, 2097152
  s_mov_b32 s55, 0x20000
  s_barrier
  buffer_load_dwordx4 v7, s[52:55], s12 offen offset:0 lds
  buffer_load_dwordx4 v7, s[52:55], s12 offen offset:1024 lds
  buffer_load_dwordx4 v7, s[52:55], s12 offen offset:2048 lds
  buffer_load_dwordx4 v7, s[52:55], s12 offen offset:3072 lds
  s_branch L_G1
L_G2:
  s_setprio 3
  s_and_b32 s13, s15, 1
  s_lshl_b32 s13, s13, 2
  v_lshrrev_b32 v10, 3, v0
  v_and_b32 v11, 7, v0
  v_and_b32 v12, 2, v10
  v_xor_b32 v11, v11, v12
  v_xor_b32 v12, 4, v11
  v_xor_b32 v11, s13, v11
  s_lshl_b32 s11, s5, 16
  s_lshl_b32 s12, s4, 7
  s_add_u32 s11, s11, s12
  s_lshl_b32 s12, s15, 14
  s_add_u32 s11, s11, s12
  v_lshl_add_u32 v10, v10, 10, s11
  v_lshl_add_u32 v3, v11, 4, v10
  v_lshl_add_u32 v4, v12, 4, v10
  v_add_u32 v4, 0xffffe000, v4
  v_cmp_gt_u32 vcc, 40, v0
  s_nop 1
  v_cndmask_b32 v4, v4, -1, vcc
  v_add_u32 v13, 0x2000, v3
  v_lshlrev_b32 v9, 4, v0
  s_mov_b32 s46, 0x200000
  s_mov_b32 s47, 0x20000
  s_mov_b32 s50, 0x200000
  s_mov_b32 s51, 0x20000
  s_mov_b32 s54, 4096
  s_mov_b32 s55, 0x20000
  s_mov_b32 s42, 0x10000000
  s_mov_b32 s43, 0x20000
  s_lshl_b32 s66, s15, 11
  s_lshl_b32 s14, s4, 9
  s_getreg_b32 s11, hwreg(HW_REG_XCC_ID, 0, 3)
  s_or_b32 s11, s11, 0x80
  v_mov_b32 v12, s11
  v_mov_b32 v11, s8
  s_lshl_b32 s67, s8, 13
  s_add_u32 s67, s67, s66
  s_add_u32 s67, s67, 2097152
  v_lshlrev_b32 v14, 7, v1
  s_add_u32 m0, s66, 1024
  s_waitcnt lgkmcnt(0)
  s_mov_b32 s44, s18
  s_mov_b32 s45, s19
  s_mov_b32 s48, s20
  s_mov_b32 s49, s21
  s_mov_b32 s52, s22
  s_mov_b32 s53, s23
  s_mov_b32 s40, s38
  s_mov_b32 s41, s39
  buffer_load_dwordx4 v3, s[44:47], 0 offen lds
  s_add_u32 m0, m0, 1024
  s_nop 0
  buffer_load_dwordx4 v13, s[44:47], 0 offen lds
  s_mov_b32 m0, 0
  s_cmp_eq_u32 s15, 0
  s_cbranch_scc1 HAL_1
  s_mov_b32 m0, 17408
  s_nop 0
  buffer_load_dwordx4 v9, s[52:55], s14 offen lds
  s_branch HAL_2
HAL_1:
  buffer_load_dwordx4 v4, s[44:47], 0 offen lds
HAL_2:
  s_add_u32 m0, s66, 9216
  s_nop 0
  buffer_load_dwordx4 v3, s[48:51], 0 offen lds
  s_add_u32 m0, m0, 1024
  s_nop 0
  buffer_load_dwordx4 v13, s[48:51], 0 offen lds
  s_mov_b64 exec, 1
  global_store_byte v11, v12, s[36:37]
  s_mov_b64 exec, -1
  buffer_load_dword v46, v14, s[40:43], s67 offen sc1
  s_load_dword s9, s[38:39], 0
  s_lshl_b32 s11, s8, 2
  s_load_dword s58, s[26:27], s11
  s_barrier
  s_mov_b32 s52, s34
  s_mov_b32 s53, s35
  s_mov_b32 s54, 2097152
  s_mov_b32 s55, 0x20000
  v_mov_b32 v5, 157696
  v_mov_b32 v6, 1
  s_lshl_b32 s11, s4, 5
  v_and_b32 v102, 7, v0
  v_lshl_add_u32 v102, v102, 2, s11
  v_and_b32 v14, 3, v0
  v_bfe_u32 v15, v0, 2, 2
  v_lshlrev_b32 v14, 3, v14
  v_lshl_add_u32 v16, v2, 4, v15
  v_add_u32 v17, 29, v16
  v_bfe_u32 v19, v17, 1, 1
  v_bfe_u32 v20, v17, 4, 1
  v_lshl_add_u32 v19, v20, 1, v19
  v_xor_b32 v19, s15, v19
  v_lshl_add_u32 v17, v17, 7, v14
  v_lshl_add_u32 v48, v19, 5, v17
  v_add_u32 v48, 4294964224, v48
  v_add_u32 v17, 33, v16
  v_bfe_u32 v19, v17, 1, 1
  v_bfe_u32 v20, v17, 4, 1
  v_lshl_add_u32 v19, v20, 1, v19
  v_xor_b32 v19, s15, v19
  v_lshl_add_u32 v17, v17, 7, v14
  v_lshl_add_u32 v49, v19, 5, v17
  v_add_u32 v49, 4294964224, v49
  v_add_u32 v17, 30, v16
  v_bfe_u32 v19, v17, 1, 1
  v_bfe_u32 v20, v17, 4, 1
  v_lshl_add_u32 v19, v20, 1, v19
  v_xor_b32 v19, s15, v19
  v_lshl_add_u32 v17, v17, 7, v14
  v_lshl_add_u32 v50, v19, 5, v17
  v_add_u32 v50, 4294964224, v50
  v_add_u32 v17, 34, v16
  v_bfe_u32 v19, v17, 1, 1
  v_bfe_u32 v20, v17, 4, 1
  v_lshl_add_u32 v19, v20, 1, v19
  v_xor_b32 v19, s15, v19
  v_lshl_add_u32 v17, v17, 7, v14
  v_lshl_add_u32 v51, v19, 5, v17
  v_add_u32 v51, 4294964224, v51
  v_add_u32 v17, 32, v16
  v_bfe_u32 v19, v17, 1, 1
  v_bfe_u32 v20, v17, 4, 1
  v_lshl_add_u32 v19, v20, 1, v19
  v_xor_b32 v19, s15, v19
  v_lshl_add_u32 v17, v17, 7, v14
  v_lshl_add_u32 v52, v19, 5, v17
  v_add_u32 v52, 4294964224, v52
  s_lshl_b32 s11, s15, 7
  v_lshl_add_u32 v53, v1, 3, s11
  v_lshlrev_b32 v54, 12, v1
  v_lshlrev_b32 v13, 5, v2
  v_sub_u32 v54, v54, v13
  v_add_u32 v54, 96, v54
  s_lshl_b32 s14, s4, 2
  s_add_u32 s14, s14, s15
  s_lshl_b32 s13, s14, 16
  s_lshl_b32 s11, s5, 7
  s_sub_u32 s13, s13, s11
  s_add_u32 s31, s13, 2101120
  s_lshl_b32 s14, s14, 5
  s_add_u32 s14, s14, s5
  s_lshl_b32 s14, s14, 2
  s_add_u32 s30, s14, 4096
  s_lshr_b32 s0, s5, 3
  s_lshl_b32 s6, s4, 2
  s_add_u32 s6, s6, s0
  s_and_b32 s7, s5, 7
  s_getreg_b32 s1, hwreg(HW_REG_XCC_ID, 0, 3)
  s_or_b32 s1, s1, 0x80
  s_mul_i32 s1, s1, 0x01010101
  s_mov_b32 s61, 0x3b000000
  s_mov_b32 s62, 0x3727c5ac
  s_mov_b32 s63, 0x3f803f80
  s_lshl_b32 s11, s6, 2
  s_add_u32 s19, s11, s15
  s_lshl_b32 s19, s19, 7
  s_lshr_b32 s12, s7, 1
  s_add_u32 s11, s11, s12
  s_lshl_b32 s11, s11, 3
  s_and_b32 s12, s7, 1
  s_add_u32 s11, s11, s12
  s_lshl_b32 s11, s11, 2
  s_add_u32 s11, s11, s15
  s_lshl_b32 s18, s11, 2
  s_mul_i32 s20, s6, 90112
  s_add_u32 s20, s20, 6291456
  s_lshl_b32 s21, s6, 16
  s_add_u32 s21, s21, 2097152
  s_lshl_b32 s23, s19, 3
  s_add_u32 s23, s23, 1048576
  s_lshl_b32 s11, s7, 7
  s_add_u32 s22, s23, s11
  s_lshl_b32 s25, s19, 6
  s_add_u32 s25, s25, s11
  s_lshl_b32 s11, s7, 12
  s_add_u32 s24, s21, s11
  s_lshr_b32 s11, s15, 1
  s_lshl_b32 s11, s11, 10
  s_add_u32 s24, s24, s11
  s_and_b32 s11, s15, 1
  s_lshl_b32 s11, s11, 7
  s_add_u32 s24, s24, s11
  s_lshl_b32 s11, s7, 13
  s_add_u32 s27, s20, s11
  s_lshl_b32 s12, s15, 11
  s_add_u32 s27, s27, s12
  v_and_b32 v40, 1, v0
  v_bfe_u32 v41, v0, 1, 1
  v_bfe_u32 v42, v0, 2, 2
  v_lshl_add_u32 v43, v2, 1, v41
  v_lshl_add_u32 v43, v43, 3, v42
  s_lshl_b32 s11, s15, 4
  s_add_u32 s11, s11, 158720
  v_lshl_add_u32 v11, v43, 6, s11
  v_lshl_add_u32 v11, v40, 3, v11
  s_lshl_b32 s11, s15, 10
  s_add_u32 s11, s11, 158720
  v_lshl_add_u32 v10, v0, 3, s11
  v_lshrrev_b32 v40, 3, v0
  v_and_b32 v41, 7, v0
  v_xor_b32 v42, v40, v41
  v_bfe_u32 v43, v0, 4, 1
  v_lshl_add_u32 v42, v43, 3, v42
  s_add_u32 s12, s12, 32768
  v_lshl_add_u32 v14, v41, 8, s12
  v_lshl_add_u32 v14, v42, 4, v14
  v_lshlrev_b32 v16, 4, v41
  v_lshl_add_u32 v16, v43, 3, v16
  v_lshrrev_b32 v42, 5, v0
  v_and_b32 v43, 3, v40
  v_lshlrev_b32 v17, 11, v42
  v_lshl_add_u32 v17, v43, 8, v17
  v_lshl_add_u32 v17, v41, 4, v17
  v_lshlrev_b32 v18, 10, v41
  v_lshl_add_u32 v18, v40, 4, v18
  s_mul_i32 s12, s15, 22528
  s_add_u32 s26, s20, s12
  s_add_u32 s57, s12, 65536
  s_lshl_b32 s11, s0, 1
  s_add_u32 s11, s11, s7
  s_mul_i32 s11, s11, 11
  s_lshr_b32 s11, s11, 2
  s_cmp_ge_u32 s11, 22
  s_cselect_b32 s13, 22, 0
  s_sub_u32 s11, s11, s13
  s_lshl_b32 s68, s11, 10
  s_lshl_b32 s11, s7, 7
  s_lshl_b32 s12, s12, 4
  s_add_u32 s69, s11, s12
  v_and_b32 v40, 31, v0
  v_and_b32 v41, 7, v0
  v_lshrrev_b32 v42, 5, v0
  v_lshl_add_u32 v42, v42, 3, v41
  s_lshl_b32 s12, s15, 13
  v_lshl_add_u32 v13, v40, 8, s12
  v_lshl_add_u32 v13, v42, 4, v13
  v_lshlrev_b32 v15, 2, v41
  v_add_u32 v19, s57, v9
  s_waitcnt vmcnt(4)
  s_mov_b64 exec, 1
  ds_add_u32 v5, v6 offset:92
  s_mov_b64 exec, -1
  global_load_dword v103, v102, s[36:37] sc1
  s_mov_b64 exec, 1
  ds_add_u32 v5, v6 offset:28
  s_mov_b64 exec, -1
  ds_read_b32 v40, v5 offset:92
  s_waitcnt lgkmcnt(0)
SK_4:
  v_cmp_gt_u32 vcc, 4, v40
  s_cbranch_vccnz SC_3
SD_5:
  ds_read_b64 v[64:65], v53 offset:17408
  ds_read_b64_tr_b16 v[66:67], v48 offset:0
  ds_read_b64_tr_b16 v[76:77], v50 offset:0
  ds_read_b64_tr_b16 v[68:69], v49 offset:0
  ds_read_b64_tr_b16 v[78:79], v51 offset:0
  ds_read_b64_tr_b16 v[70:71], v49 offset:512
  ds_read_b64_tr_b16 v[80:81], v51 offset:512
  ds_read_b64_tr_b16 v[72:73], v49 offset:1024
  ds_read_b64_tr_b16 v[82:83], v51 offset:1024
  ds_read_b64_tr_b16 v[74:75], v49 offset:1536
  ds_read_b64_tr_b16 v[84:85], v51 offset:1536
  s_waitcnt vmcnt(3)
  s_mov_b64 exec, 1
  ds_add_u32 v5, v6 offset:96
  s_mov_b64 exec, -1
  s_waitcnt lgkmcnt(7)
  v_alignbit_b32 v64, v64, v64, 16
  v_alignbit_b32 v65, v65, v65, 16
  v_dot2_f32_bf16 v116, v66, v65, 0
  v_dot2_f32_bf16 v117, v76, v65, 0
  v_dot2_f32_bf16 v118, v67, v65, 0
  v_dot2_f32_bf16 v119, v77, v65, 0
  v_dot2_f32_bf16 v116, v67, v64, v116
  v_dot2_f32_bf16 v117, v77, v64, v117
  v_dot2_f32_bf16 v118, v68, v64, v118
  v_dot2_f32_bf16 v119, v78, v64, v119
  s_waitcnt lgkmcnt(5)
  v_dot2_f32_bf16 v120, v68, v65, 0
  v_dot2_f32_bf16 v121, v78, v65, 0
  v_dot2_f32_bf16 v122, v69, v65, 0
  v_dot2_f32_bf16 v123, v79, v65, 0
  v_dot2_f32_bf16 v120, v69, v64, v120
  v_dot2_f32_bf16 v121, v79, v64, v121
  v_dot2_f32_bf16 v122, v70, v64, v122
  v_dot2_f32_bf16 v123, v80, v64, v123
  s_waitcnt lgkmcnt(3)
  v_dot2_f32_bf16 v124, v70, v65, 0
  v_dot2_f32_bf16 v125, v80, v65, 0
  v_dot2_f32_bf16 v126, v71, v65, 0
  v_dot2_f32_bf16 v127, v81, v65, 0
  v_dot2_f32_bf16 v124, v71, v64, v124
  v_dot2_f32_bf16 v125, v81, v64, v125
  v_dot2_f32_bf16 v126, v72, v64, v126
  v_dot2_f32_bf16 v127, v82, v64, v127
  s_waitcnt lgkmcnt(1)
  v_dot2_f32_bf16 v128, v72, v65, 0
  v_dot2_f32_bf16 v129, v82, v65, 0
  v_dot2_f32_bf16 v130, v73, v65, 0
  v_dot2_f32_bf16 v131, v83, v65, 0
  v_dot2_f32_bf16 v128, v73, v64, v128
  v_dot2_f32_bf16 v129, v83, v64, v129
  v_dot2_f32_bf16 v130, v74, v64, v130
  v_dot2_f32_bf16 v131, v84, v64, v131
  ds_read_b32 v40, v5 offset:96
  s_waitcnt lgkmcnt(0)
SK_7:
  v_cmp_gt_u32 vcc, 4, v40
  s_cbranch_vccnz SC_6
SD_8:
  ds_read_b64_tr_b16 v[132:133], v52 offset:8192
  ds_read_b64_tr_b16 v[134:135], v52 offset:8704
  ds_read_b64_tr_b16 v[136:137], v52 offset:9216
  ds_read_b64_tr_b16 v[138:139], v52 offset:9728
  s_waitcnt lgkmcnt(3)
  v_lshlrev_b32 v140, 16, v132
  v_and_b32 v141, 0xffff0000, v132
  v_lshlrev_b32 v142, 16, v133
  v_and_b32 v143, 0xffff0000, v133
  v_mul_f32 v116, v116, v140
  v_mul_f32 v117, v117, v141
  v_mul_f32 v118, v118, v142
  v_mul_f32 v119, v119, v143
  s_waitcnt lgkmcnt(2)
  v_lshlrev_b32 v144, 16, v134
  v_and_b32 v145, 0xffff0000, v134
  v_lshlrev_b32 v146, 16, v135
  v_and_b32 v147, 0xffff0000, v135
  v_mul_f32 v120, v120, v144
  v_mul_f32 v121, v121, v145
  v_mul_f32 v122, v122, v146
  v_mul_f32 v123, v123, v147
  s_waitcnt lgkmcnt(1)
  v_lshlrev_b32 v148, 16, v136
  v_and_b32 v149, 0xffff0000, v136
  v_lshlrev_b32 v150, 16, v137
  v_and_b32 v151, 0xffff0000, v137
  v_mul_f32 v124, v124, v148
  v_mul_f32 v125, v125, v149
  v_mul_f32 v126, v126, v150
  v_mul_f32 v127, v127, v151
  s_waitcnt lgkmcnt(0)
  v_lshlrev_b32 v152, 16, v138
  v_and_b32 v153, 0xffff0000, v138
  v_lshlrev_b32 v154, 16, v139
  v_and_b32 v155, 0xffff0000, v139
  v_mul_f32 v128, v128, v152
  v_mul_f32 v129, v129, v153
  v_mul_f32 v130, v130, v154
  v_mul_f32 v131, v131, v155
  v_cvt_pk_bf16_f32 v108, v131, v130
  v_cvt_pk_bf16_f32 v109, v129, v128
  v_cvt_pk_bf16_f32 v110, v127, v126
  v_cvt_pk_bf16_f32 v111, v125, v124
  v_cvt_pk_bf16_f32 v112, v123, v122
  v_cvt_pk_bf16_f32 v113, v121, v120
  v_cvt_pk_bf16_f32 v114, v119, v118
  v_cvt_pk_bf16_f32 v115, v117, v116
  buffer_store_dwordx4 v[108:111], v54, s[40:43], s31 offen offset:0
  buffer_store_dwordx4 v[112:115], v54, s[40:43], s31 offen offset:16
  s_mul_i32 s9, s9, 1664525
  s_add_u32 s9, s9, 1013904223
  v_mov_b32 v7, s9
  s_lshl_b32 s59, s58, 16
  s_and_b32 s60, s58, 0xffff0000
  s_lshr_b32 s64, s15, 1
  s_and_b32 s65, s15, 1
  s_mul_i32 s12, s64, 8320
  s_add_u32 s12, s12, 65536
  s_mul_i32 s13, s64, 4608
  s_add_u32 s13, s13, 82176
  v_lshl_add_u32 v40, v0, 3, s13
  v_mov_b32 v42, 0
  v_mov_b32 v43, 0
  ds_write_b64 v40, v[42:43] offset:4096
  v_lshl_add_u32 v40, v2, 3, v1
  v_and_b32 v41, 1, v1
  v_lshlrev_b32 v40, 1, v40
  v_add_u32 v42, 2, v40
  v_add_u32 v43, 4160, v40
  v_cmp_eq_u32 vcc, 1, v41
  s_nop 1
  v_cndmask_b32 v40, v43, v42, vcc
  s_lshl_b32 s14, s65, 8
  s_add_u32 s12, s12, s14
  v_add_u32 v97, s12, v40
  s_add_u32 s13, s13, s14
  s_add_u32 s13, s13, 480
  v_lshl_add_u32 v40, v2, 4, s13
  v_lshlrev_b32 v41, 5, v1
  v_sub_u32 v96, v40, v41
  v_lshl_add_u32 v40, v1, 2, v2
  s_lshl_b32 s13, s15, 9
  s_sub_u32 s14, 84216, s13
  v_lshlrev_b32 v41, 3, v40
  v_sub_u32 v98, s14, v41
  s_lshl_b32 s11, s15, 12
  s_add_u32 s11, s11, 65536
  v_add_u32 v99, s11, v9
  s_lshl_b32 s11, s15, 10
  s_add_u32 s11, s11, 65536
  v_add_u32 v100, s11, v9
  s_mov_b32 s11, 90112
  v_lshrrev_b32 v41, 1, v1
  v_mul_lo_u32 v41, v41, s11
  v_and_b32 v40, 7, v40
  v_lshl_add_u32 v101, v40, 4, v41
  s_mul_i32 s11, s64, 4608
  s_lshl_b32 s13, s65, 11
  s_add_u32 s11, s11, s13
  s_add_u32 m0, s11, 82176
  s_lshl_b32 s12, s6, 7
  s_add_u32 s12, s12, 4096
  v_and_b32 v12, 31, v0
  v_lshlrev_b32 v12, 2, v12
  s_waitcnt vmcnt(0)
  s_mov_b32 s11, 40
MK_10:
  s_mov_b32 s28, 32
  v_cmp_ne_u32 vcc, s1, v103
  s_cbranch_vccnz MC_9
MD_11:
  s_cmp_eq_u32 s28, 32
  s_cbranch_scc0 UW_12
UD_13:
  s_mov_b64 exec, 1
  s_cmp_eq_u32 s28, 32
  s_cbranch_scc0 LC_14
  buffer_store_dword v7, off, s[40:43], s30
LD_15:
  s_mov_b64 exec, -1
  ds_read_b32 v40, v5 offset:0
  s_waitcnt lgkmcnt(0)
SK_17:
  v_cmp_gt_u32 vcc, 4, v40
  s_cbranch_vccnz SC_16
SD_18:
  ds_read2_b32 v[128:129], v97 offset0:0 offset1:1
  ds_read2_b32 v[130:131], v97 offset0:2 offset1:3
  ds_read2_b32 v[160:161], v97 offset0:16 offset1:17
  ds_read2_b32 v[162:163], v97 offset0:18 offset1:19
  ds_read2_b32 v[192:193], v97 offset0:32 offset1:33
  ds_read2_b32 v[194:195], v97 offset0:34 offset1:35
  ds_read2_b32 v[224:225], v97 offset0:48 offset1:49
  ds_read2_b32 v[226:227], v97 offset0:50 offset1:51
  ds_read2_b32 v[132:133], v97 offset0:128 offset1:129
  ds_read2_b32 v[134:135], v97 offset0:130 offset1:131
  ds_read2_b32 v[164:165], v97 offset0:144 offset1:145
  ds_read2_b32 v[166:167], v97 offset0:146 offset1:147
  ds_read2_b32 v[196:197], v97 offset0:160 offset1:161
  ds_read2_b32 v[198:199], v97 offset0:162 offset1:163
  ds_read2_b32 v[228:229], v97 offset0:176 offset1:177
  ds_read2_b32 v[230:231], v97 offset0:178 offset1:179
  v_add_u32 v97, 1024, v97
  buffer_load_dword v40, v12, s[40:43], s12 offen sc1
  ds_read2_b32 v[136:137], v97 offset0:0 offset1:1
  ds_read2_b32 v[138:139], v97 offset0:2 offset1:3
  ds_read2_b32 v[168:169], v97 offset0:16 offset1:17
  ds_read2_b32 v[170:171], v97 offset0:18 offset1:19
  ds_read2_b32 v[200:201], v97 offset0:32 offset1:33
  ds_read2_b32 v[202:203], v97 offset0:34 offset1:35
  ds_read2_b32 v[232:233], v97 offset0:48 offset1:49
  ds_read2_b32 v[234:235], v97 offset0:50 offset1:51
  ds_read2_b32 v[140:141], v97 offset0:128 offset1:129
  ds_read2_b32 v[142:143], v97 offset0:130 offset1:131
  ds_read2_b32 v[172:173], v97 offset0:144 offset1:145
  ds_read2_b32 v[174:175], v97 offset0:146 offset1:147
  ds_read2_b32 v[204:205], v97 offset0:160 offset1:161
  ds_read2_b32 v[206:207], v97 offset0:162 offset1:163
  ds_read2_b32 v[236:237], v97 offset0:176 offset1:177
  ds_read2_b32 v[238:239], v97 offset0:178 offset1:179
  v_add_u32 v97, 1024, v97
  s_waitcnt vmcnt(0)
SK_20:
  v_cmp_ne_u32 vcc, s9, v40
  s_cbranch_vccnz SC_19
SD_21:
  buffer_load_dwordx4 v9, s[40:43], s67 offen offset:0 sc1 lds
  buffer_load_dwordx4 v9, s[40:43], s67 offen offset:1024 sc1 lds
  s_waitcnt vmcnt(0)
  s_mov_b64 exec, 1
  ds_add_u32 v5, v6 offset:4
  s_mov_b64 exec, -1
  ds_read_b32 v42, v5 offset:4
  s_waitcnt lgkmcnt(0)
SK_23:
  v_cmp_gt_u32 vcc, 4, v42
  s_cbranch_vccnz SC_22
SD_24:
  s_add_u32 s11, s25, 0
  v_add_u32 v36, s11, v18
  global_load_dwordx4 v[28:31], v36, s[16:17]
  s_add_u32 s11, s25, 1048576
  v_add_u32 v36, s11, v18
  global_load_dwordx4 v[20:23], v36, s[16:17]
  s_mov_b64 exec, 1
  ds_add_u32 v5, v6 offset:20
  s_mov_b64 exec, -1
  ds_read_b128 v[80:83], v96 offset:3584
  ds_read_b128 v[84:87], v96 offset:3072
  ds_read_b128 v[88:91], v96 offset:2560
  ds_read_b128 v[92:95], v96 offset:2048
  ds_read_b128 v[64:67], v96 offset:3648
  ds_read_b128 v[68:71], v96 offset:3136
  ds_read_b128 v[72:75], v96 offset:2624
  ds_read_b128 v[76:79], v96 offset:2112
  s_waitcnt lgkmcnt(7)
  v_mfma_f32_16x16x32_bf16 v[48:51], v[128:131], v[80:83], 0
  v_mfma_f32_16x16x32_bf16 v[52:55], v[132:135], v[80:83], 0
  v_mfma_f32_16x16x32_bf16 v[56:59], v[136:139], v[80:83], 0
  v_mfma_f32_16x16x32_bf16 v[60:63], v[140:143], v[80:83], 0
  ds_read2_b32 v[144:145], v97 offset0:0 offset1:1
  ds_read2_b32 v[146:147], v97 offset0:2 offset1:3
  ds_read_b128 v[80:83], v96 offset:3712
  s_waitcnt lgkmcnt(9)
  v_mfma_f32_16x16x32_bf16 v[52:55], v[128:131], v[84:87], v[52:55]
  v_mfma_f32_16x16x32_bf16 v[56:59], v[132:135], v[84:87], v[56:59]
  v_mfma_f32_16x16x32_bf16 v[60:63], v[136:139], v[84:87], v[60:63]
  ds_read2_b32 v[176:177], v97 offset0:16 offset1:17
  ds_read2_b32 v[178:179], v97 offset0:18 offset1:19
  ds_read_b128 v[84:87], v96 offset:3200
  s_waitcnt lgkmcnt(11)
  v_mfma_f32_16x16x32_bf16 v[56:59], v[128:131], v[88:91], v[56:59]
  v_mfma_f32_16x16x32_bf16 v[60:63], v[132:135], v[88:91], v[60:63]
  ds_read2_b32 v[208:209], v97 offset0:32 offset1:33
  ds_read2_b32 v[210:211], v97 offset0:34 offset1:35
  ds_read_b128 v[88:91], v96 offset:2688
  s_waitcnt lgkmcnt(12)
  v_mfma_f32_16x16x32_bf16 v[60:63], v[128:131], v[92:95], v[60:63]
  ds_read2_b32 v[240:241], v97 offset0:48 offset1:49
  ds_read2_b32 v[242:243], v97 offset0:50 offset1:51
  ds_read_b128 v[92:95], v96 offset:2176
  s_waitcnt lgkmcnt(12)
  v_mfma_f32_16x16x32_bf16 v[48:51], v[160:163], v[64:67], v[48:51]
  v_mfma_f32_16x16x32_bf16 v[52:55], v[164:167], v[64:67], v[52:55]
  v_mfma_f32_16x16x32_bf16 v[56:59], v[168:171], v[64:67], v[56:59]
  v_mfma_f32_16x16x32_bf16 v[60:63], v[172:175], v[64:67], v[60:63]
  ds_read2_b32 v[148:149], v97 offset0:128 offset1:129
  ds_read2_b32 v[150:151], v97 offset0:130 offset1:131
  ds_read_b128 v[64:67], v96 offset:3776
  s_waitcnt lgkmcnt(12)
  v_mfma_f32_16x16x32_bf16 v[52:55], v[160:163], v[68:71], v[52:55]
  v_mfma_f32_16x16x32_bf16 v[56:59], v[164:167], v[68:71], v[56:59]
  v_mfma_f32_16x16x32_bf16 v[60:63], v[168:171], v[68:71], v[60:63]
  ds_read2_b32 v[180:181], v97 offset0:144 offset1:145
  ds_read2_b32 v[182:183], v97 offset0:146 offset1:147
  ds_read_b128 v[68:71], v96 offset:3264
  s_waitcnt lgkmcnt(12)
  v_mfma_f32_16x16x32_bf16 v[56:59], v[160:163], v[72:75], v[56:59]
  v_mfma_f32_16x16x32_bf16 v[60:63], v[164:167], v[72:75], v[60:63]
  ds_read2_b32 v[212:213], v97 offset0:160 offset1:161
  ds_read2_b32 v[214:215], v97 offset0:162 offset1:163
  ds_read_b128 v[72:75], v96 offset:2752
  s_waitcnt lgkmcnt(12)
  v_mfma_f32_16x16x32_bf16 v[60:63], v[160:163], v[76:79], v[60:63]
  ds_read2_b32 v[244:245], v97 offset0:176 offset1:177
  ds_read2_b32 v[246:247], v97 offset0:178 offset1:179
  ds_read_b128 v[76:79], v96 offset:2240
  s_waitcnt lgkmcnt(12)
  v_mfma_f32_16x16x32_bf16 v[48:51], v[192:195], v[80:83], v[48:51]
  v_mfma_f32_16x16x32_bf16 v[52:55], v[196:199], v[80:83], v[52:55]
  v_mfma_f32_16x16x32_bf16 v[56:59], v[200:203], v[80:83], v[56:59]
  v_mfma_f32_16x16x32_bf16 v[60:63], v[204:207], v[80:83], v[60:63]
  v_add_u32 v97, 1024, v97
  ds_read2_b32 v[152:153], v97 offset0:0 offset1:1
  ds_read2_b32 v[154:155], v97 offset0:2 offset1:3
  s_waitcnt lgkmcnt(12)
  v_mfma_f32_16x16x32_bf16 v[52:55], v[192:195], v[84:87], v[52:55]
  v_mfma_f32_16x16x32_bf16 v[56:59], v[196:199], v[84:87], v[56:59]
  v_mfma_f32_16x16x32_bf16 v[60:63], v[200:203], v[84:87], v[60:63]
  ds_read2_b32 v[184:185], v97 offset0:16 offset1:17
  ds_read2_b32 v[186:187], v97 offset0:18 offset1:19
  s_waitcnt lgkmcnt(12)
  v_mfma_f32_16x16x32_bf16 v[56:59], v[192:195], v[88:91], v[56:59]
  v_mfma_f32_16x16x32_bf16 v[60:63], v[196:199], v[88:91], v[60:63]
  ds_read2_b32 v[216:217], v97 offset0:32 offset1:33
  ds_read2_b32 v[218:219], v97 offset0:34 offset1:35
  s_waitcnt lgkmcnt(12)
  v_mfma_f32_16x16x32_bf16 v[60:63], v[192:195], v[92:95], v[60:63]
  ds_read2_b32 v[248:249], v97 offset0:48 offset1:49
  ds_read2_b32 v[250:251], v97 offset0:50 offset1:51
  s_waitcnt lgkmcnt(12)
  v_mfma_f32_16x16x32_bf16 v[48:51], v[224:227], v[64:67], v[48:51]
  v_mfma_f32_16x16x32_bf16 v[52:55], v[228:231], v[64:67], v[52:55]
  v_mfma_f32_16x16x32_bf16 v[56:59], v[232:235], v[64:67], v[56:59]
  v_mfma_f32_16x16x32_bf16 v[60:63], v[236:239], v[64:67], v[60:63]
  ds_read2_b32 v[156:157], v97 offset0:128 offset1:129
  ds_read2_b32 v[158:159], v97 offset0:130 offset1:131
  s_waitcnt lgkmcnt(12)
  v_mfma_f32_16x16x32_bf16 v[52:55], v[224:227], v[68:71], v[52:55]
  v_mfma_f32_16x16x32_bf16 v[56:59], v[228:231], v[68:71], v[56:59]
  v_mfma_f32_16x16x32_bf16 v[60:63], v[232:235], v[68:71], v[60:63]
  ds_read2_b32 v[188:189], v97 offset0:144 offset1:145
  ds_read2_b32 v[190:191], v97 offset0:146 offset1:147
  s_waitcnt lgkmcnt(12)
  v_mfma_f32_16x16x32_bf16 v[56:59], v[224:227], v[72:75], v[56:59]
  v_mfma_f32_16x16x32_bf16 v[60:63], v[228:231], v[72:75], v[60:63]
  ds_read2_b32 v[220:221], v97 offset0:160 offset1:161
  ds_read2_b32 v[222:223], v97 offset0:162 offset1:163
  s_waitcnt lgkmcnt(12)
  v_mfma_f32_16x16x32_bf16 v[60:63], v[224:227], v[76:79], v[60:63]
  ds_read2_b32 v[252:253], v97 offset0:176 offset1:177
  ds_read2_b32 v[254:255], v97 offset0:178 offset1:179
  s_setprio 3
  ds_read_b64 v[40:41], v98 offset:2048
  ds_read_b64 v[42:43], v98 offset:6656
  ds_write_b128 v99, v[48:51] offset:25856
  ds_write_b128 v99, v[52:55] offset:26880
  ds_write_b128 v99, v[56:59] offset:27904
  ds_write_b128 v99, v[60:63] offset:28928
  s_mov_b64 exec, 1
  ds_add_u32 v5, v6 offset:8
  s_mov_b64 exec, -1
  s_waitcnt lgkmcnt(5)
  v_and_b32 v104, 0xffff0000, v41
  v_lshlrev_b32 v105, 16, v41
  v_and_b32 v106, 0xffff0000, v40
  v_lshlrev_b32 v107, 16, v40
  v_and_b32 v108, 0xffff0000, v43
  v_lshlrev_b32 v109, 16, v43
  v_and_b32 v110, 0xffff0000, v42
  v_lshlrev_b32 v111, 16, v42
  v_mov_b32 v113, v7
  v_mov_b32 v115, v7
  v_mov_b32 v117, v7
  v_mov_b32 v119, v7
  s_mul_i32 s11, s15, 720896
  s_lshl_b32 s12, s8, 8
  s_add_u32 s11, s11, s12
  s_add_u32 s11, s11, 6291456
  ds_read_b32 v44, v5 offset:8
  s_waitcnt lgkmcnt(0)
SK_26:
  v_cmp_gt_u32 vcc, 4, v44
  s_cbranch_vccnz SC_25
SD_27:
  ds_read_b128 v[48:51], v100 offset:25856
  ds_read_b128 v[52:55], v100 offset:29952
  ds_read_b128 v[56:59], v100 offset:34048
  ds_read_b128 v[60:63], v100 offset:38144
  s_waitcnt lgkmcnt(2)
  v_fma_f32 v104, v104, s59, v48
  v_fma_f32 v105, v105, s59, v49
  v_fma_f32 v106, v106, s59, v50
  v_fma_f32 v107, v107, s59, v51
  v_add_f32 v104, v104, v52
  v_add_f32 v105, v105, v53
  v_add_f32 v106, v106, v54
  v_add_f32 v107, v107, v55
  v_cvt_pk_bf16_f32 v112, v104, v105
  v_cvt_pk_bf16_f32 v114, v106, v107
  buffer_store_dwordx4 v[112:115], v101, s[40:43], s11 offen offset:0 sc1
  s_waitcnt lgkmcnt(0)
  v_fma_f32 v108, v108, s60, v56
  v_fma_f32 v109, v109, s60, v57
  v_fma_f32 v110, v110, s60, v58
  v_fma_f32 v111, v111, s60, v59
  v_add_f32 v108, v108, v60
  v_add_f32 v109, v109, v61
  v_add_f32 v110, v110, v62
  v_add_f32 v111, v111, v63
  v_cvt_pk_bf16_f32 v116, v108, v109
  v_cvt_pk_bf16_f32 v118, v110, v111
  buffer_store_dwordx4 v[116:119], v101, s[40:43], s11 offen offset:128 sc1
  s_waitcnt vmcnt(2)
  v_dot2_f32_bf16 v36, v20, s63, 0
  v_dot2_f32_bf16 v38, v20, v20, 0
  v_dot2_f32_bf16 v36, v21, s63, v36
  v_dot2_f32_bf16 v38, v21, v21, v38
  v_dot2_f32_bf16 v36, v22, s63, v36
  v_dot2_f32_bf16 v38, v22, v22, v38
  v_dot2_f32_bf16 v36, v23, s63, v36
  v_dot2_f32_bf16 v38, v23, v23, v38
  s_add_u32 s11, s22, 131072
  v_xor_b32 v37, 0, v7
  v_add_f32 v36, v36, v36 row_ror:8
  v_add_f32 v38, v38, v38 row_ror:8
  s_nop 1
  v_permlane16_swap_b32 v36, v38
  v_add_f32 v36, v36, v38
  v_mov_b32 v39, v36
  s_nop 1
  v_permlane32_swap_b32 v36, v39
  v_add_f32 v36, v36, v39
  s_mov_b64 exec, 0xff00ff
  s_cmp_eq_u32 s28, 32
  s_cbranch_scc0 LC_28
  buffer_store_dwordx2 v[36:37], v16, s[40:43], s11 offen
LD_29:
  s_mov_b64 exec, -1
  v_dot2_f32_bf16 v36, v28, s63, 0
  v_dot2_f32_bf16 v38, v28, v28, 0
  v_dot2_f32_bf16 v36, v29, s63, v36
  v_dot2_f32_bf16 v38, v29, v29, v38
  v_dot2_f32_bf16 v36, v30, s63, v36
  v_dot2_f32_bf16 v38, v30, v30, v38
  v_dot2_f32_bf16 v36, v31, s63, v36
  v_dot2_f32_bf16 v38, v31, v31, v38
  s_add_u32 s11, s22, 0
  v_xor_b32 v37, 0, v7
  v_add_f32 v36, v36, v36 row_ror:8
  v_add_f32 v38, v38, v38 row_ror:8
  s_nop 1
  v_permlane16_swap_b32 v36, v38
  v_add_f32 v36, v36, v38
  v_mov_b32 v39, v36
  s_nop 1
  v_permlane32_swap_b32 v36, v39
  v_add_f32 v36, v36, v39
  s_mov_b64 exec, 0xff00ff
  s_cmp_eq_u32 s28, 32
  s_cbranch_scc0 LC_30
  buffer_store_dwordx2 v[36:37], v16, s[40:43], s11 offen
LD_31:
  s_mov_b64 exec, -1
  s_setprio 0
  ds_read_b128 v[80:83], v96 offset:3584
  ds_read_b128 v[84:87], v96 offset:3072
  ds_read_b128 v[88:91], v96 offset:2560
  ds_read_b128 v[92:95], v96 offset:2048
  ds_read_b128 v[48:51], v96 offset:1536
  ds_read_b128 v[52:55], v96 offset:1024
  ds_read_b128 v[56:59], v96 offset:512
  ds_read_b128 v[60:63], v96 offset:0
  s_waitcnt lgkmcnt(7)
  v_mfma_f32_16x16x32_bf16 v[64:67], v[144:147], v[80:83], 0
  v_mfma_f32_16x16x32_bf16 v[68:71], v[148:151], v[80:83], 0
  v_mfma_f32_16x16x32_bf16 v[72:75], v[152:155], v[80:83], 0
  v_mfma_f32_16x16x32_bf16 v[76:79], v[156:159], v[80:83], 0
  ds_read_b128 v[80:83], v96 offset:3648
  s_waitcnt lgkmcnt(7)
  v_mfma_f32_16x16x32_bf16 v[64:67], v[140:143], v[84:87], v[64:67]
  v_mfma_f32_16x16x32_bf16 v[68:71], v[144:147], v[84:87], v[68:71]
  v_mfma_f32_16x16x32_bf16 v[72:75], v[148:151], v[84:87], v[72:75]
  v_mfma_f32_16x16x32_bf16 v[76:79], v[152:155], v[84:87], v[76:79]
  ds_read_b128 v[84:87], v96 offset:3136
  s_waitcnt lgkmcnt(7)
  v_mfma_f32_16x16x32_bf16 v[64:67], v[136:139], v[88:91], v[64:67]
  v_mfma_f32_16x16x32_bf16 v[68:71], v[140:143], v[88:91], v[68:71]
  v_mfma_f32_16x16x32_bf16 v[72:75], v[144:147], v[88:91], v[72:75]
  v_mfma_f32_16x16x32_bf16 v[76:79], v[148:151], v[88:91], v[76:79]
  ds_read_b128 v[88:91], v96 offset:2624
  s_waitcnt lgkmcnt(7)
  v_mfma_f32_16x16x32_bf16 v[64:67], v[132:135], v[92:95], v[64:67]
  v_mfma_f32_16x16x32_bf16 v[68:71], v[136:139], v[92:95], v[68:71]
  v_mfma_f32_16x16x32_bf16 v[72:75], v[140:143], v[92:95], v[72:75]
  v_mfma_f32_16x16x32_bf16 v[76:79], v[144:147], v[92:95], v[76:79]
  ds_read_b128 v[92:95], v96 offset:2112
  s_waitcnt lgkmcnt(7)
  v_mfma_f32_16x16x32_bf16 v[64:67], v[128:131], v[48:51], v[64:67]
  v_mfma_f32_16x16x32_bf16 v[68:71], v[132:135], v[48:51], v[68:71]
  v_mfma_f32_16x16x32_bf16 v[72:75], v[136:139], v[48:51], v[72:75]
  v_mfma_f32_16x16x32_bf16 v[76:79], v[140:143], v[48:51], v[76:79]
  ds_read_b128 v[48:51], v96 offset:1600
  s_waitcnt lgkmcnt(7)
  v_mfma_f32_16x16x32_bf16 v[68:71], v[128:131], v[52:55], v[68:71]
  v_mfma_f32_16x16x32_bf16 v[72:75], v[132:135], v[52:55], v[72:75]
  v_mfma_f32_16x16x32_bf16 v[76:79], v[136:139], v[52:55], v[76:79]
  ds_read_b128 v[52:55], v96 offset:1088
  s_waitcnt lgkmcnt(7)
  v_mfma_f32_16x16x32_bf16 v[72:75], v[128:131], v[56:59], v[72:75]
  v_mfma_f32_16x16x32_bf16 v[76:79], v[132:135], v[56:59], v[76:79]
  ds_read_b128 v[56:59], v96 offset:576
  s_waitcnt lgkmcnt(7)
  v_mfma_f32_16x16x32_bf16 v[76:79], v[128:131], v[60:63], v[76:79]
  ds_read_b128 v[60:63], v96 offset:64
  s_waitcnt lgkmcnt(7)
  v_mfma_f32_16x16x32_bf16 v[64:67], v[176:179], v[80:83], v[64:67]
  v_mfma_f32_16x16x32_bf16 v[68:71], v[180:183], v[80:83], v[68:71]
  v_mfma_f32_16x16x32_bf16 v[72:75], v[184:187], v[80:83], v[72:75]
  v_mfma_f32_16x16x32_bf16 v[76:79], v[188:191], v[80:83], v[76:79]
  ds_read_b128 v[80:83], v96 offset:3712
  s_waitcnt lgkmcnt(7)
  v_mfma_f32_16x16x32_bf16 v[64:67], v[172:175], v[84:87], v[64:67]
  v_mfma_f32_16x16x32_bf16 v[68:71], v[176:179], v[84:87], v[68:71]
  v_mfma_f32_16x16x32_bf16 v[72:75], v[180:183], v[84:87], v[72:75]
  v_mfma_f32_16x16x32_bf16 v[76:79], v[184:187], v[84:87], v[76:79]
  ds_read_b128 v[84:87], v96 offset:3200
  s_waitcnt lgkmcnt(7)
  v_mfma_f32_16x16x32_bf16 v[64:67], v[168:171], v[88:91], v[64:67]
  v_mfma_f32_16x16x32_bf16 v[68:71], v[172:175], v[88:91], v[68:71]
  v_mfma_f32_16x16x32_bf16 v[72:75], v[176:179], v[88:91], v[72:75]
  v_mfma_f32_16x16x32_bf16 v[76:79], v[180:183], v[88:91], v[76:79]
  ds_read_b128 v[88:91], v96 offset:2688
  s_waitcnt lgkmcnt(7)
  v_mfma_f32_16x16x32_bf16 v[64:67], v[164:167], v[92:95], v[64:67]
  v_mfma_f32_16x16x32_bf16 v[68:71], v[168:171], v[92:95], v[68:71]
  v_mfma_f32_16x16x32_bf16 v[72:75], v[172:175], v[92:95], v[72:75]
  v_mfma_f32_16x16x32_bf16 v[76:79], v[176:179], v[92:95], v[76:79]
  ds_read_b128 v[92:95], v96 offset:2176
  s_waitcnt lgkmcnt(7)
  v_mfma_f32_16x16x32_bf16 v[64:67], v[160:163], v[48:51], v[64:67]
  v_mfma_f32_16x16x32_bf16 v[68:71], v[164:167], v[48:51], v[68:71]
  v_mfma_f32_16x16x32_bf16 v[72:75], v[168:171], v[48:51], v[72:75]
  v_mfma_f32_16x16x32_bf16 v[76:79], v[172:175], v[48:51], v[76:79]
  ds_read_b128 v[48:51], v96 offset:1664
  s_waitcnt lgkmcnt(7)
  v_mfma_f32_16x16x32_bf16 v[68:71], v[160:163], v[52:55], v[68:71]
  v_mfma_f32_16x16x32_bf16 v[72:75], v[164:167], v[52:55], v[72:75]
  v_mfma_f32_16x16x32_bf16 v[76:79], v[168:171], v[52:55], v[76:79]
  ds_read_b128 v[52:55], v96 offset:1152
  s_waitcnt lgkmcnt(7)
  v_mfma_f32_16x16x32_bf16 v[72:75], v[160:163], v[56:59], v[72:75]
  v_mfma_f32_16x16x32_bf16 v[76:79], v[164:167], v[56:59], v[76:79]
  ds_read_b128 v[56:59], v96 offset:640
  s_waitcnt lgkmcnt(7)
  v_mfma_f32_16x16x32_bf16 v[76:79], v[160:163], v[60:63], v[76:79]
  ds_read_b128 v[60:63], v96 offset:128
  s_waitcnt lgkmcnt(7)
  v_mfma_f32_16x16x32_bf16 v[64:67], v[208:211], v[80:83], v[64:67]
  v_mfma_f32_16x16x32_bf16 v[68:71], v[212:215], v[80:83], v[68:71]
  v_mfma_f32_16x16x32_bf16 v[72:75], v[216:219], v[80:83], v[72:75]
  v_mfma_f32_16x16x32_bf16 v[76:79], v[220:223], v[80:83], v[76:79]
  ds_read_b128 v[80:83], v96 offset:3776
  s_waitcnt lgkmcnt(7)
  v_mfma_f32_16x16x32_bf16 v[64:67], v[204:207], v[84:87], v[64:67]
  v_mfma_f32_16x16x32_bf16 v[68:71], v[208:211], v[84:87], v[68:71]
  v_mfma_f32_16x16x32_bf16 v[72:75], v[212:215], v[84:87], v[72:75]
  v_mfma_f32_16x16x32_bf16 v[76:79], v[216:219], v[84:87], v[76:79]
  ds_read_b128 v[84:87], v96 offset:3264
  s_waitcnt lgkmcnt(7)
  v_mfma_f32_16x16x32_bf16 v[64:67], v[200:203], v[88:91], v[64:67]
  v_mfma_f32_16x16x32_bf16 v[68:71], v[204:207], v[88:91], v[68:71]
  v_mfma_f32_16x16x32_bf16 v[72:75], v[208:211], v[88:91], v[72:75]
  v_mfma_f32_16x16x32_bf16 v[76:79], v[212:215], v[88:91], v[76:79]
  ds_read_b128 v[88:91], v96 offset:2752
  s_waitcnt lgkmcnt(7)
  v_mfma_f32_16x16x32_bf16 v[64:67], v[196:199], v[92:95], v[64:67]
  v_mfma_f32_16x16x32_bf16 v[68:71], v[200:203], v[92:95], v[68:71]
  v_mfma_f32_16x16x32_bf16 v[72:75], v[204:207], v[92:95], v[72:75]
  v_mfma_f32_16x16x32_bf16 v[76:79], v[208:211], v[92:95], v[76:79]
  ds_read_b128 v[92:95], v96 offset:2240
  s_waitcnt lgkmcnt(7)
  v_mfma_f32_16x16x32_bf16 v[64:67], v[192:195], v[48:51], v[64:67]
  v_mfma_f32_16x16x32_bf16 v[68:71], v[196:199], v[48:51], v[68:71]
  v_mfma_f32_16x16x32_bf16 v[72:75], v[200:203], v[48:51], v[72:75]
  v_mfma_f32_16x16x32_bf16 v[76:79], v[204:207], v[48:51], v[76:79]
  ds_read_b128 v[48:51], v96 offset:1728
  s_waitcnt lgkmcnt(7)
  v_mfma_f32_16x16x32_bf16 v[68:71], v[192:195], v[52:55], v[68:71]
  v_mfma_f32_16x16x32_bf16 v[72:75], v[196:199], v[52:55], v[72:75]
  v_mfma_f32_16x16x32_bf16 v[76:79], v[200:203], v[52:55], v[76:79]
  ds_read_b128 v[52:55], v96 offset:1216
  s_waitcnt lgkmcnt(7)
  v_mfma_f32_16x16x32_bf16 v[72:75], v[192:195], v[56:59], v[72:75]
  v_mfma_f32_16x16x32_bf16 v[76:79], v[196:199], v[56:59], v[76:79]
  s_setprio 3
  s_add_u32 s13, s27, 0
  buffer_load_dwordx4 v[120:123], v9, s[40:43], s13 offen offset:0 sc1
  buffer_load_dwordx4 v[124:127], v9, s[40:43], s13 offen offset:1024 sc1
  s_add_u32 s13, s23, 0
  buffer_load_dwordx4 v[36:39], v9, s[40:43], s13 offen sc1
  s_setprio 0
  ds_read_b128 v[56:59], v96 offset:704
  s_waitcnt lgkmcnt(7)
  v_mfma_f32_16x16x32_bf16 v[76:79], v[192:195], v[60:63], v[76:79]
  ds_read_b128 v[60:63], v96 offset:192
  s_waitcnt lgkmcnt(7)
  v_mfma_f32_16x16x32_bf16 v[64:67], v[240:243], v[80:83], v[64:67]
  v_mfma_f32_16x16x32_bf16 v[68:71], v[244:247], v[80:83], v[68:71]
  v_mfma_f32_16x16x32_bf16 v[72:75], v[248:251], v[80:83], v[72:75]
  v_mfma_f32_16x16x32_bf16 v[76:79], v[252:255], v[80:83], v[76:79]
  s_waitcnt lgkmcnt(6)
  v_mfma_f32_16x16x32_bf16 v[64:67], v[236:239], v[84:87], v[64:67]
  v_mfma_f32_16x16x32_bf16 v[68:71], v[240:243], v[84:87], v[68:71]
  v_mfma_f32_16x16x32_bf16 v[72:75], v[244:247], v[84:87], v[72:75]
  v_mfma_f32_16x16x32_bf16 v[76:79], v[248:251], v[84:87], v[76:79]
  s_waitcnt lgkmcnt(5)
  v_mfma_f32_16x16x32_bf16 v[64:67], v[232:235], v[88:91], v[64:67]
  v_mfma_f32_16x16x32_bf16 v[68:71], v[236:239], v[88:91], v[68:71]
  v_mfma_f32_16x16x32_bf16 v[72:75], v[240:243], v[88:91], v[72:75]
  v_mfma_f32_16x16x32_bf16 v[76:79], v[244:247], v[88:91], v[76:79]
  s_waitcnt lgkmcnt(4)
  v_mfma_f32_16x16x32_bf16 v[64:67], v[228:231], v[92:95], v[64:67]
  v_mfma_f32_16x16x32_bf16 v[68:71], v[232:235], v[92:95], v[68:71]
  v_mfma_f32_16x16x32_bf16 v[72:75], v[236:239], v[92:95], v[72:75]
  v_mfma_f32_16x16x32_bf16 v[76:79], v[240:243], v[92:95], v[76:79]
  s_waitcnt lgkmcnt(3)
  v_mfma_f32_16x16x32_bf16 v[64:67], v[224:227], v[48:51], v[64:67]
  v_mfma_f32_16x16x32_bf16 v[68:71], v[228:231], v[48:51], v[68:71]
  v_mfma_f32_16x16x32_bf16 v[72:75], v[232:235], v[48:51], v[72:75]
  v_mfma_f32_16x16x32_bf16 v[76:79], v[236:239], v[48:51], v[76:79]
  s_waitcnt lgkmcnt(2)
  v_mfma_f32_16x16x32_bf16 v[68:71], v[224:227], v[52:55], v[68:71]
  v_mfma_f32_16x16x32_bf16 v[72:75], v[228:231], v[52:55], v[72:75]
  v_mfma_f32_16x16x32_bf16 v[76:79], v[232:235], v[52:55], v[76:79]
  s_waitcnt lgkmcnt(1)
  v_mfma_f32_16x16x32_bf16 v[72:75], v[224:227], v[56:59], v[72:75]
  v_mfma_f32_16x16x32_bf16 v[76:79], v[228:231], v[56:59], v[76:79]
  s_waitcnt lgkmcnt(0)
  v_mfma_f32_16x16x32_bf16 v[76:79], v[224:227], v[60:63], v[76:79]
  s_setprio 3
  ds_read_b64 v[40:41], v98 offset:0
  ds_read_b64 v[42:43], v98 offset:4608
  ds_write_b128 v99, v[64:67] offset:0
  ds_write_b128 v99, v[68:71] offset:1024
  ds_write_b128 v99, v[72:75] offset:2048
  s_nop 1
  ds_write_b128 v99, v[76:79] offset:3072
  s_mov_b64 exec, 1
  ds_add_u32 v5, v6 offset:12
  s_mov_b64 exec, -1
  s_waitcnt lgkmcnt(5)
  v_and_b32 v104, 0xffff0000, v41
  v_lshlrev_b32 v105, 16, v41
  v_and_b32 v106, 0xffff0000, v40
  v_lshlrev_b32 v107, 16, v40
  v_and_b32 v108, 0xffff0000, v43
  v_lshlrev_b32 v109, 16, v43
  v_and_b32 v110, 0xffff0000, v42
  v_lshlrev_b32 v111, 16, v42
  v_mov_b32 v113, v7
  v_mov_b32 v115, v7
  v_mov_b32 v117, v7
  v_mov_b32 v119, v7
  s_waitcnt vmcnt(0)
SK_33:
  v_xor_b32 v40, s9, v121
  v_xor_b32 v41, s9, v123
  v_xor_b32 v42, s9, v125
  v_xor_b32 v43, s9, v127
  v_or3_b32 v40, v40, v41, v42
  v_or_b32 v40, v40, v43
  v_cmp_ne_u32 vcc, 0, v40
  s_cbranch_vccnz SC_32
SD_34:
  ds_write2_b32 v10, v120, v122 offset0:0 offset1:1
  ds_write2_b32 v10, v124, v126 offset0:128 offset1:129
  s_mov_b64 exec, 1
  ds_add_u32 v5, v6 offset:100
  s_mov_b64 exec, -1
  v_lshlrev_b32 v48, 16, v28
  v_and_b32 v49, 0xffff0000, v28
  v_lshlrev_b32 v50, 16, v29
  v_and_b32 v51, 0xffff0000, v29
  v_lshlrev_b32 v52, 16, v30
  v_and_b32 v53, 0xffff0000, v30
  v_lshlrev_b32 v54, 16, v31
  v_and_b32 v55, 0xffff0000, v31
SK_36:
  v_xor_b32 v37, v7, v37
  v_xor_b32 v39, v7, v39
  v_or_b32 v37, v37, v39
  v_cmp_ne_u32 vcc, 0, v37
  s_cbranch_vccnz SC_35
SD_37:
  v_add_f32 v36, v36, v36 row_ror:8
  v_add_f32 v38, v38, v38 row_ror:8
  s_nop 1
  v_permlane16_swap_b32 v36, v38
  v_add_f32 v36, v36, v38
  v_mov_b32 v39, v36
  s_nop 1
  v_permlane32_swap_b32 v36, v39
  v_add_f32 v36, v36, v39
  v_mov_b32 v38, v36
  s_nop 1
  v_permlane16_swap_b32 v36, v38
  v_mul_f32 v36, s61, v36
  v_mul_f32 v38, s61, v38
  v_fma_f32 v38, -v36, v36, v38
  v_max_f32 v38, 0, v38
  v_add_f32 v38, s62, v38
  v_rsq_f32 v38, v38
  s_nop 0
  v_mul_f32 v36, -v36, v38
  v_fma_f32 v64, v48, v38, v36
  v_fma_f32 v65, v49, v38, v36
  v_fma_f32 v66, v50, v38, v36
  v_fma_f32 v67, v51, v38, v36
  v_fma_f32 v68, v52, v38, v36
  v_fma_f32 v69, v53, v38, v36
  v_fma_f32 v70, v54, v38, v36
  v_fma_f32 v71, v55, v38, v36
  ds_read_b32 v40, v5 offset:100
  s_waitcnt lgkmcnt(0)
SK_39:
  v_cmp_gt_u32 vcc, 4, v40
  s_cbranch_vccnz SC_38
SD_40:
  ds_read_b64_tr_b16 v[24:25], v11 offset:0
  ds_read_b64_tr_b16 v[26:27], v11 offset:256
  s_waitcnt lgkmcnt(0)
  v_lshlrev_b32 v56, 16, v24
  v_and_b32 v57, 0xffff0000, v24
  v_lshlrev_b32 v58, 16, v25
  v_and_b32 v59, 0xffff0000, v25
  v_lshlrev_b32 v60, 16, v26
  v_and_b32 v61, 0xffff0000, v26
  v_lshlrev_b32 v62, 16, v27
  v_and_b32 v63, 0xffff0000, v27
  v_fma_f32 v48, v64, v56, v48
  v_fma_f32 v49, v65, v57, v49
  v_fma_f32 v50, v66, v58, v50
  v_fma_f32 v51, v67, v59, v51
  v_fma_f32 v52, v68, v60, v52
  v_fma_f32 v53, v69, v61, v53
  v_fma_f32 v54, v70, v62, v54
  v_fma_f32 v55, v71, v63, v55
  v_cvt_pk_bf16_f32 v28, v48, v49
  v_cvt_pk_bf16_f32 v29, v50, v51
  v_cvt_pk_bf16_f32 v30, v52, v53
  v_cvt_pk_bf16_f32 v31, v54, v55
  s_add_u32 s11, s24, 0
  s_cmp_eq_u32 s28, 32
  s_cbranch_scc0 LC_41
  buffer_store_dwordx4 v[28:31], v17, s[40:43], s11 offen
LD_42:
  v_add_f32 v36, v48, v49
  v_mul_f32 v38, v48, v48
  v_add_f32 v37, v50, v51
  v_mul_f32 v39, v49, v49
  v_fmac_f32 v38, v50, v50
  v_fmac_f32 v39, v51, v51
  v_fmac_f32 v38, v52, v52
  v_add_f32 v36, v36, v52
  v_fmac_f32 v39, v53, v53
  v_add_f32 v37, v37, v53
  v_fmac_f32 v38, v54, v54
  v_add_f32 v36, v36, v54
  v_fmac_f32 v39, v55, v55
  v_add_f32 v37, v37, v55
  v_add_f32 v36, v36, v37
  v_add_f32 v38, v38, v39
  s_add_u32 s11, s22, 262144
  v_xor_b32 v37, 0, v7
  v_add_f32 v36, v36, v36 row_ror:8
  v_add_f32 v38, v38, v38 row_ror:8
  s_nop 1
  v_permlane16_swap_b32 v36, v38
  v_add_f32 v36, v36, v38
  v_mov_b32 v39, v36
  s_nop 1
  v_permlane32_swap_b32 v36, v39
  v_add_f32 v36, v36, v39
  s_mov_b64 exec, 0xff00ff
  s_cmp_eq_u32 s28, 32
  s_cbranch_scc0 LC_43
  buffer_store_dwordx2 v[36:37], v16, s[40:43], s11 offen
LD_44:
  s_mov_b64 exec, -1
  s_mul_i32 s11, s15, 720896
  s_lshl_b32 s12, s8, 8
  s_add_u32 s11, s11, s12
  s_add_u32 s11, s11, 9175040
  ds_read_b32 v44, v5 offset:12
  s_waitcnt lgkmcnt(0)
SK_46:
  v_cmp_gt_u32 vcc, 4, v44
  s_cbranch_vccnz SC_45
SD_47:
  ds_read_b128 v[64:67], v100 offset:0
  ds_read_b128 v[68:71], v100 offset:4096
  ds_read_b128 v[72:75], v100 offset:8192
  ds_read_b128 v[76:79], v100 offset:12288
  s_waitcnt lgkmcnt(2)
  v_fma_f32 v104, v104, s59, v64
  v_fma_f32 v105, v105, s59, v65
  v_fma_f32 v106, v106, s59, v66
  v_fma_f32 v107, v107, s59, v67
  v_add_f32 v104, v104, v68
  v_add_f32 v105, v105, v69
  v_add_f32 v106, v106, v70
  v_add_f32 v107, v107, v71
  v_cvt_pk_bf16_f32 v112, v104, v105
  v_cvt_pk_bf16_f32 v114, v106, v107
  buffer_store_dwordx4 v[112:115], v101, s[40:43], s11 offen offset:0 sc1
  s_waitcnt lgkmcnt(0)
  v_fma_f32 v108, v108, s60, v72
  v_fma_f32 v109, v109, s60, v73
  v_fma_f32 v110, v110, s60, v74
  v_fma_f32 v111, v111, s60, v75
  v_add_f32 v108, v108, v76
  v_add_f32 v109, v109, v77
  v_add_f32 v110, v110, v78
  v_add_f32 v111, v111, v79
  v_cvt_pk_bf16_f32 v116, v108, v109
  v_cvt_pk_bf16_f32 v118, v110, v111
  buffer_store_dwordx4 v[116:119], v101, s[40:43], s11 offen offset:128 sc1
  s_mov_b64 exec, 1
  ds_add_u32 v5, v6 offset:16
  s_mov_b64 exec, -1
  s_waitcnt vmcnt(3)
  s_add_u32 s11, s18, 81920
  s_mov_b64 exec, 1
  s_cmp_eq_u32 s28, 32
  s_cbranch_scc0 LC_48
  buffer_store_dword v7, off, s[40:43], s11
LD_49:
  s_mov_b64 exec, -1
  s_add_u32 s11, s57, 20480
  v_lshl_add_u32 v10, v0, 3, s11
  s_movk_i32 s11, 21504
  v_mul_u32_u24 v40, s11, v2
  v_add_u32 v11, v40, v11
  v_add_u32 v11, 4294894592, v11
L_W2:
  s_mov_b32 s48, s32
  s_mov_b32 s49, s33
  s_mov_b32 s50, 1409024
  v_lshrrev_b32 v40, 3, v0
  v_and_b32 v41, 7, v0
  v_and_b32 v42, 2, v40
  v_lshlrev_b32 v42, 1, v42
  v_xor_b32 v41, v41, v42
  v_lshlrev_b32 v44, 10, v40
  v_lshl_add_u32 v44, v41, 4, v44
  v_add_u32 v45, 0x2000, v44
  v_and_b32 v40, 3, v0
  v_bfe_u32 v41, v0, 2, 2
  v_bfe_u32 v42, v0, 4, 1
  v_lshrrev_b32 v43, 5, v0
  v_lshl_add_u32 v43, v43, 3, v41
  v_lshl_add_u32 v46, v43, 7, s57
  v_lshl_add_u32 v46, v42, 5, v46
  v_lshl_add_u32 v46, v40, 3, v46
  v_bfe_u32 v41, v0, 3, 1
  v_lshl_add_u32 v46, v41, 6, v46
  v_xor_b32 v47, 64, v46
  ds_read_b32 v36, v5 offset:16
  s_waitcnt lgkmcnt(0)
SK_51:
  v_cmp_gt_u32 vcc, 4, v36
  s_cbranch_vccnz SC_50
SD_52:
  s_lshr_b32 s12, s15, 1
  s_mul_i32 s12, s12, 2883584
  s_lshl_b32 s11, s7, 1
  s_add_u32 s11, s11, s65
  s_mul_i32 s11, s11, 1536
  s_add_u32 s11, s11, s12
  s_add_u32 s11, s11, s20
  s_add_u32 s58, s11, 0x10000
  v_min_u32 v41, 11, v0
  v_lshlrev_b32 v12, 7, v41
  s_add_u32 s14, s19, 81920
  s_lshl_b32 s13, s15, 13
  s_add_u32 m0, s13, 0
  s_add_u32 s12, s21, s13
  s_add_u32 s12, s12, 0
  buffer_load_dword v36, v15, s[40:43], s14 offen sc1
  s_waitcnt vmcnt(0)
SK_54:
  v_cmp_ne_u32 vcc, s9, v36
  s_cbranch_vccnz SC_53
SD_55:
  buffer_load_dwordx4 v9, s[40:43], s12 offen offset:0 sc1 lds
  buffer_load_dwordx4 v9, s[40:43], s12 offen offset:1024 sc1 lds
  buffer_load_dwordx4 v9, s[40:43], s12 offen offset:2048 sc1 lds
  buffer_load_dwordx4 v9, s[40:43], s12 offen offset:3072 sc1 lds
  s_add_u32 s12, s12, 4096
  s_add_u32 m0, m0, 4096
  s_nop 0
  buffer_load_dwordx4 v9, s[40:43], s12 offen offset:0 sc1 lds
  buffer_load_dwordx4 v9, s[40:43], s12 offen offset:1024 sc1 lds
  buffer_load_dwordx4 v9, s[40:43], s12 offen offset:2048 sc1 lds
  buffer_load_dwordx4 v9, s[40:43], s12 offen offset:3072 sc1 lds
  s_waitcnt vmcnt(0)
  s_mov_b64 exec, 1
  ds_add_u32 v5, v6 offset:32
  s_mov_b64 exec, -1
  ds_read_b32 v36, v5 offset:24
  s_waitcnt lgkmcnt(0)
SK_57:
  v_cmp_gt_u32 vcc, 4, v36
  s_cbranch_vccnz SC_56
SD_58:
  s_setprio 0
  s_lshl_b32 s58, s68, 4
  s_add_u32 s13, s27, 2883584
  buffer_load_dwordx4 v[72:75], v9, s[40:43], s13 offen offset:0 sc1
  buffer_load_dwordx4 v[76:79], v9, s[40:43], s13 offen offset:1024 sc1
  s_add_u32 s13, s23, 131072
  buffer_load_dwordx4 v[36:39], v9, s[40:43], s13 offen sc1
  s_add_u32 s12, s69, s58
  s_add_u32 m0, s57, 16384
  s_nop 0
  buffer_load_dwordx4 v44, s[48:51], s12 offen lds
  s_add_u32 m0, m0, 1024
  s_nop 0
  buffer_load_dwordx4 v45, s[48:51], s12 offen lds
  s_add_u32 s58, s58, 0x4000
  s_cmp_eq_u32 s58, 360448
  s_cselect_b32 s58, 0, s58
  s_add_u32 s12, s69, s58
  s_add_u32 m0, s57, 18432
  s_nop 0
  buffer_load_dwordx4 v44, s[48:51], s12 offen lds
  s_add_u32 m0, m0, 1024
  s_nop 0
  buffer_load_dwordx4 v45, s[48:51], s12 offen lds
  s_add_u32 s58, s58, 0x4000
  s_cmp_eq_u32 s58, 360448
  s_cselect_b32 s58, 0, s58
  s_add_u32 s12, s69, s58
  s_add_u32 m0, s57, 0
  s_nop 0
  buffer_load_dwordx4 v44, s[48:51], s12 offen lds
  s_add_u32 m0, m0, 1024
  s_nop 0
  buffer_load_dwordx4 v45, s[48:51], s12 offen lds
  s_add_u32 s58, s58, 0x4000
  s_cmp_eq_u32 s58, 360448
  s_cselect_b32 s58, 0, s58
  s_add_u32 s12, s69, s58
  s_add_u32 m0, s57, 2048
  s_nop 0
  buffer_load_dwordx4 v44, s[48:51], s12 offen lds
  s_add_u32 m0, m0, 1024
  s_nop 0
  buffer_load_dwordx4 v45, s[48:51], s12 offen lds
  s_add_u32 s58, s58, 0x4000
  s_cmp_eq_u32 s58, 360448
  s_cselect_b32 s58, 0, s58
  s_setprio 3
  s_waitcnt vmcnt(8)
SK_60:
  v_xor_b32 v40, s9, v73
  v_xor_b32 v41, s9, v75
  v_xor_b32 v42, s9, v77
  v_xor_b32 v43, s9, v79
  v_or3_b32 v40, v40, v41, v42
  v_or_b32 v40, v40, v43
  v_cmp_ne_u32 vcc, 0, v40
  s_cbranch_vccnz SC_59
SD_61:
  ds_write2_b32 v10, v72, v74 offset0:0 offset1:1
  ds_write2_b32 v10, v76, v78 offset0:128 offset1:129
  s_mov_b64 exec, 1
  ds_add_u32 v5, v6 offset:104
  s_mov_b64 exec, -1
  v_lshlrev_b32 v48, 16, v20
  v_and_b32 v49, 0xffff0000, v20
  v_lshlrev_b32 v50, 16, v21
  v_and_b32 v51, 0xffff0000, v21
  v_lshlrev_b32 v52, 16, v22
  v_and_b32 v53, 0xffff0000, v22
  v_lshlrev_b32 v54, 16, v23
  v_and_b32 v55, 0xffff0000, v23
SK_63:
  v_xor_b32 v37, v7, v37
  v_xor_b32 v39, v7, v39
  v_or_b32 v37, v37, v39
  v_cmp_ne_u32 vcc, 0, v37
  s_cbranch_vccnz SC_62
SD_64:
  v_add_f32 v36, v36, v36 row_ror:8
  v_add_f32 v38, v38, v38 row_ror:8
  s_nop 1
  v_permlane16_swap_b32 v36, v38
  v_add_f32 v36, v36, v38
  v_mov_b32 v39, v36
  s_nop 1
  v_permlane32_swap_b32 v36, v39
  v_add_f32 v36, v36, v39
  v_mov_b32 v38, v36
  s_nop 1
  v_permlane16_swap_b32 v36, v38
  v_mul_f32 v36, s61, v36
  v_mul_f32 v38, s61, v38
  v_fma_f32 v38, -v36, v36, v38
  v_max_f32 v38, 0, v38
  v_add_f32 v38, s62, v38
  v_rsq_f32 v38, v38
  s_nop 0
  v_mul_f32 v36, -v36, v38
  v_fma_f32 v64, v48, v38, v36
  v_fma_f32 v65, v49, v38, v36
  v_fma_f32 v66, v50, v38, v36
  v_fma_f32 v67, v51, v38, v36
  v_fma_f32 v68, v52, v38, v36
  v_fma_f32 v69, v53, v38, v36
  v_fma_f32 v70, v54, v38, v36
  v_fma_f32 v71, v55, v38, v36
  ds_read_b32 v40, v5 offset:104
  s_waitcnt lgkmcnt(0)
SK_66:
  v_cmp_gt_u32 vcc, 4, v40
  s_cbranch_vccnz SC_65
SD_67:
  ds_read_b64_tr_b16 v[24:25], v11 offset:0
  ds_read_b64_tr_b16 v[26:27], v11 offset:256
  s_waitcnt lgkmcnt(0)
  v_lshlrev_b32 v56, 16, v24
  v_and_b32 v57, 0xffff0000, v24
  v_lshlrev_b32 v58, 16, v25
  v_and_b32 v59, 0xffff0000, v25
  v_lshlrev_b32 v60, 16, v26
  v_and_b32 v61, 0xffff0000, v26
  v_lshlrev_b32 v62, 16, v27
  v_and_b32 v63, 0xffff0000, v27
  v_fma_f32 v48, v64, v56, v48
  v_fma_f32 v49, v65, v57, v49
  v_fma_f32 v50, v66, v58, v50
  v_fma_f32 v51, v67, v59, v51
  v_fma_f32 v52, v68, v60, v52
  v_fma_f32 v53, v69, v61, v53
  v_fma_f32 v54, v70, v62, v54
  v_fma_f32 v55, v71, v63, v55
  v_cvt_pk_bf16_f32 v20, v48, v49
  v_cvt_pk_bf16_f32 v21, v50, v51
  v_cvt_pk_bf16_f32 v22, v52, v53
  v_cvt_pk_bf16_f32 v23, v54, v55
  s_add_u32 s11, s24, 32768
  s_cmp_eq_u32 s28, 32
  s_cbranch_scc0 LC_68
  buffer_store_dwordx4 v[20:23], v17, s[40:43], s11 offen
LD_69:
  v_add_f32 v36, v48, v49
  v_mul_f32 v38, v48, v48
  v_add_f32 v37, v50, v51
  v_mul_f32 v39, v49, v49
  v_fmac_f32 v38, v50, v50
  v_fmac_f32 v39, v51, v51
  v_fmac_f32 v38, v52, v52
  v_add_f32 v36, v36, v52
  v_fmac_f32 v39, v53, v53
  v_add_f32 v37, v37, v53
  v_fmac_f32 v38, v54, v54
  v_add_f32 v36, v36, v54
  v_fmac_f32 v39, v55, v55
  v_add_f32 v37, v37, v55
  v_add_f32 v36, v36, v37
  v_add_f32 v38, v38, v39
  s_add_u32 s11, s22, 393216
  v_xor_b32 v37, 0, v7
  v_add_f32 v36, v36, v36 row_ror:8
  v_add_f32 v38, v38, v38 row_ror:8
  s_nop 1
  v_permlane16_swap_b32 v36, v38
  v_add_f32 v36, v36, v38
  v_mov_b32 v39, v36
  s_nop 1
  v_permlane32_swap_b32 v36, v39
  v_add_f32 v36, v36, v39
  s_mov_b64 exec, 0xff00ff
  s_cmp_eq_u32 s28, 32
  s_cbranch_scc0 LC_70
  buffer_store_dwordx2 v[36:37], v16, s[40:43], s11 offen
LD_71:
  s_mov_b64 exec, -1
  s_mov_b64 exec, 1
  ds_add_u32 v5, v6 offset:16
  s_mov_b64 exec, -1
  s_setprio 0
  s_waitcnt vmcnt(8)
  ds_read_b64_tr_b16 v[80:81], v46 offset:16384
  ds_read_b64_tr_b16 v[82:83], v46 offset:16896
  ds_read_b64_tr_b16 v[84:85], v47 offset:16384
  ds_read_b64_tr_b16 v[86:87], v47 offset:16896
  s_add_u32 s12, s69, s58
  s_add_u32 m0, s57, 4096
  s_nop 0
  buffer_load_dwordx4 v44, s[48:51], s12 offen lds
  s_add_u32 m0, m0, 1024
  s_nop 0
  buffer_load_dwordx4 v45, s[48:51], s12 offen lds
  s_add_u32 s58, s58, 0x4000
  s_cmp_eq_u32 s58, 360448
  s_cselect_b32 s58, 0, s58
  s_waitcnt vmcnt(8)
  ds_read_b64_tr_b16 v[88:89], v46 offset:18432
  ds_read_b64_tr_b16 v[90:91], v46 offset:18944
  ds_read_b64_tr_b16 v[92:93], v47 offset:18432
  ds_read_b64_tr_b16 v[94:95], v47 offset:18944
  s_add_u32 s12, s69, s58
  s_add_u32 m0, s57, 6144
  s_nop 0
  buffer_load_dwordx4 v44, s[48:51], s12 offen lds
  s_add_u32 m0, m0, 1024
  s_nop 0
  buffer_load_dwordx4 v45, s[48:51], s12 offen lds
  s_add_u32 s58, s58, 0x4000
  s_cmp_eq_u32 s58, 360448
  s_cselect_b32 s58, 0, s58
  s_waitcnt vmcnt(8)
  ds_read_b64_tr_b16 v[96:97], v46 offset:0
  ds_read_b64_tr_b16 v[98:99], v46 offset:512
  ds_read_b64_tr_b16 v[100:101], v47 offset:0
  ds_read_b64_tr_b16 v[102:103], v47 offset:512
  s_add_u32 s12, s69, s58
  s_add_u32 m0, s57, 8192
  s_nop 0
  buffer_load_dwordx4 v44, s[48:51], s12 offen lds
  s_add_u32 m0, m0, 1024
  s_nop 0
  buffer_load_dwordx4 v45, s[48:51], s12 offen lds
  s_add_u32 s58, s58, 0x4000
  s_cmp_eq_u32 s58, 360448
  s_cselect_b32 s58, 0, s58
  s_waitcnt vmcnt(8)
  ds_read_b64_tr_b16 v[104:105], v46 offset:2048
  ds_read_b64_tr_b16 v[106:107], v46 offset:2560
  ds_read_b64_tr_b16 v[108:109], v47 offset:2048
  ds_read_b64_tr_b16 v[110:111], v47 offset:2560
  s_waitcnt vmcnt(7)
  s_add_u32 s11, s18, 98304
  s_mov_b64 exec, 1
  s_cmp_eq_u32 s28, 32
  s_cbranch_scc0 LC_72
  buffer_store_dword v7, off, s[40:43], s11
LD_73:
  s_mov_b64 exec, -1
  s_add_u32 s12, s69, s58
  s_add_u32 m0, s57, 10240
  s_nop 0
  buffer_load_dwordx4 v44, s[48:51], s12 offen lds
  s_add_u32 m0, m0, 1024
  s_nop 0
  buffer_load_dwordx4 v45, s[48:51], s12 offen lds
  s_add_u32 s58, s58, 0x4000
  s_cmp_eq_u32 s58, 360448
  s_cselect_b32 s58, 0, s58
  s_waitcnt vmcnt(7)
  ds_read_b64_tr_b16 v[112:113], v46 offset:4096
  ds_read_b64_tr_b16 v[114:115], v46 offset:4608
  ds_read_b64_tr_b16 v[116:117], v47 offset:4096
  ds_read_b64_tr_b16 v[118:119], v47 offset:4608
  s_add_u32 s14, s19, 98304
  buffer_load_dword v12, v15, s[40:43], s14 offen sc1
  s_add_u32 s12, s69, s58
  s_add_u32 m0, s57, 12288
  s_nop 0
  buffer_load_dwordx4 v44, s[48:51], s12 offen lds
  s_add_u32 m0, m0, 1024
  s_nop 0
  buffer_load_dwordx4 v45, s[48:51], s12 offen lds
  s_add_u32 s58, s58, 0x4000
  s_cmp_eq_u32 s58, 360448
  s_cselect_b32 s58, 0, s58
  s_waitcnt vmcnt(8)
  ds_read_b64_tr_b16 v[120:121], v46 offset:6144
  ds_read_b64_tr_b16 v[122:123], v46 offset:6656
  ds_read_b64_tr_b16 v[124:125], v47 offset:6144
  ds_read_b64_tr_b16 v[126:127], v47 offset:6656
  s_add_u32 s12, s69, s58
  s_add_u32 m0, s57, 14336
  s_nop 0
  buffer_load_dwordx4 v44, s[48:51], s12 offen lds
  s_add_u32 m0, m0, 1024
  s_nop 0
  buffer_load_dwordx4 v45, s[48:51], s12 offen lds
  s_add_u32 s58, s58, 0x4000
  s_cmp_eq_u32 s58, 360448
  s_cselect_b32 s58, 0, s58
  s_waitcnt vmcnt(8)
  ds_read_b64_tr_b16 v[128:129], v46 offset:8192
  ds_read_b64_tr_b16 v[130:131], v46 offset:8704
  ds_read_b64_tr_b16 v[132:133], v47 offset:8192
  ds_read_b64_tr_b16 v[134:135], v47 offset:8704
  s_waitcnt lgkmcnt(12)
  s_add_u32 s12, s69, s58
  s_add_u32 m0, s57, 16384
  s_nop 0
  buffer_load_dwordx4 v44, s[48:51], s12 offen lds
  s_add_u32 m0, m0, 1024
  s_nop 0
  buffer_load_dwordx4 v45, s[48:51], s12 offen lds
  s_add_u32 s58, s58, 0x4000
  s_cmp_eq_u32 s58, 360448
  s_cselect_b32 s58, 0, s58
  s_waitcnt vmcnt(7)
  ds_read_b64_tr_b16 v[136:137], v46 offset:10240
  ds_read_b64_tr_b16 v[138:139], v46 offset:10752
  ds_read_b64_tr_b16 v[140:141], v47 offset:10240
  ds_read_b64_tr_b16 v[142:143], v47 offset:10752
  s_waitcnt vmcnt(6)
SK_75:
  v_cmp_ne_u32 vcc, s9, v12
  s_cbranch_vccnz SC_74
SD_76:
  s_lshl_b32 s13, s15, 13
  s_add_u32 m0, s13, 32768
  s_add_u32 s12, s21, s13
  s_add_u32 s12, s12, 32768
  buffer_load_dwordx4 v9, s[40:43], s12 offen offset:0 sc1 lds
  buffer_load_dwordx4 v9, s[40:43], s12 offen offset:1024 sc1 lds
  buffer_load_dwordx4 v9, s[40:43], s12 offen offset:2048 sc1 lds
  buffer_load_dwordx4 v9, s[40:43], s12 offen offset:3072 sc1 lds
  s_add_u32 s12, s12, 4096
  s_add_u32 m0, m0, 4096
  s_nop 0
  buffer_load_dwordx4 v9, s[40:43], s12 offen offset:0 sc1 lds
  buffer_load_dwordx4 v9, s[40:43], s12 offen offset:1024 sc1 lds
  buffer_load_dwordx4 v9, s[40:43], s12 offen offset:2048 sc1 lds
  buffer_load_dwordx4 v9, s[40:43], s12 offen offset:3072 sc1 lds
  s_waitcnt lgkmcnt(12)
  s_add_u32 s12, s69, s58
  s_add_u32 m0, s57, 18432
  s_nop 0
  buffer_load_dwordx4 v44, s[48:51], s12 offen lds
  s_add_u32 m0, m0, 1024
  s_nop 0
  buffer_load_dwordx4 v45, s[48:51], s12 offen lds
  s_add_u32 s58, s58, 0x4000
  s_cmp_eq_u32 s58, 360448
  s_cselect_b32 s58, 0, s58
  s_waitcnt vmcnt(14)
  ds_read_b64_tr_b16 v[144:145], v46 offset:12288
  ds_read_b64_tr_b16 v[146:147], v46 offset:12800
  ds_read_b64_tr_b16 v[148:149], v47 offset:12288
  ds_read_b64_tr_b16 v[150:151], v47 offset:12800
  s_waitcnt lgkmcnt(12)
  s_add_u32 s12, s69, s58
  s_add_u32 m0, s57, 0
  s_nop 0
  buffer_load_dwordx4 v44, s[48:51], s12 offen lds
  s_add_u32 m0, m0, 1024
  s_nop 0
  buffer_load_dwordx4 v45, s[48:51], s12 offen lds
  s_add_u32 s58, s58, 0x4000
  s_cmp_eq_u32 s58, 360448
  s_cselect_b32 s58, 0, s58
  s_waitcnt vmcnt(14)
  ds_read_b64_tr_b16 v[152:153], v46 offset:14336
  ds_read_b64_tr_b16 v[154:155], v46 offset:14848
  ds_read_b64_tr_b16 v[156:157], v47 offset:14336
  ds_read_b64_tr_b16 v[158:159], v47 offset:14848
  s_waitcnt lgkmcnt(12)
  s_add_u32 s12, s69, s58
  s_add_u32 m0, s57, 2048
  s_nop 0
  buffer_load_dwordx4 v44, s[48:51], s12 offen lds
  s_add_u32 m0, m0, 1024
  s_nop 0
  buffer_load_dwordx4 v45, s[48:51], s12 offen lds
  s_add_u32 s58, s58, 0x4000
  s_cmp_eq_u32 s58, 360448
  s_cselect_b32 s58, 0, s58
  s_waitcnt vmcnt(14)
  ds_read_b64_tr_b16 v[160:161], v46 offset:16384
  ds_read_b64_tr_b16 v[162:163], v46 offset:16896
  ds_read_b64_tr_b16 v[164:165], v47 offset:16384
  ds_read_b64_tr_b16 v[166:167], v47 offset:16896
  s_waitcnt vmcnt(6)
  s_mov_b64 exec, 1
  ds_add_u32 v5, v6 offset:36
  s_mov_b64 exec, -1
  s_waitcnt lgkmcnt(12)
  s_add_u32 s12, s69, s58
  s_add_u32 m0, s57, 4096
  s_nop 0
  buffer_load_dwordx4 v44, s[48:51], s12 offen lds
  s_add_u32 m0, m0, 1024
  s_nop 0
  buffer_load_dwordx4 v45, s[48:51], s12 offen lds
  s_add_u32 s58, s58, 0x4000
  s_cmp_eq_u32 s58, 360448
  s_cselect_b32 s58, 0, s58
  s_waitcnt vmcnt(6)
  ds_read_b64_tr_b16 v[168:169], v46 offset:18432
  ds_read_b64_tr_b16 v[170:171], v46 offset:18944
  ds_read_b64_tr_b16 v[172:173], v47 offset:18432
  ds_read_b64_tr_b16 v[174:175], v47 offset:18944
  s_waitcnt lgkmcnt(12)
  s_add_u32 s12, s69, s58
  s_add_u32 m0, s57, 6144
  s_nop 0
  buffer_load_dwordx4 v44, s[48:51], s12 offen lds
  s_add_u32 m0, m0, 1024
  s_nop 0
  buffer_load_dwordx4 v45, s[48:51], s12 offen lds
  s_add_u32 s58, s58, 0x4000
  s_cmp_eq_u32 s58, 360448
  s_cselect_b32 s58, 0, s58
  s_waitcnt vmcnt(6)
  ds_read_b64_tr_b16 v[176:177], v46 offset:0
  ds_read_b64_tr_b16 v[178:179], v46 offset:512
  ds_read_b64_tr_b16 v[180:181], v47 offset:0
  ds_read_b64_tr_b16 v[182:183], v47 offset:512
  s_waitcnt lgkmcnt(12)
  s_add_u32 s12, s69, s58
  s_add_u32 m0, s57, 8192
  s_nop 0
  buffer_load_dwordx4 v44, s[48:51], s12 offen lds
  s_add_u32 m0, m0, 1024
  s_nop 0
  buffer_load_dwordx4 v45, s[48:51], s12 offen lds
  s_add_u32 s58, s58, 0x4000
  s_cmp_eq_u32 s58, 360448
  s_cselect_b32 s58, 0, s58
  s_waitcnt vmcnt(6)
  ds_read_b64_tr_b16 v[184:185], v46 offset:2048
  ds_read_b64_tr_b16 v[186:187], v46 offset:2560
  ds_read_b64_tr_b16 v[188:189], v47 offset:2048
  ds_read_b64_tr_b16 v[190:191], v47 offset:2560
  s_add_u32 s13, s23, 393216
  buffer_load_dwordx4 v[36:39], v9, s[40:43], s13 offen sc1
  s_waitcnt lgkmcnt(12)
  s_add_u32 s12, s69, s58
  s_add_u32 m0, s57, 10240
  s_nop 0
  buffer_load_dwordx4 v44, s[48:51], s12 offen lds
  s_add_u32 m0, m0, 1024
  s_nop 0
  buffer_load_dwordx4 v45, s[48:51], s12 offen lds
  s_add_u32 s58, s58, 0x4000
  s_cmp_eq_u32 s58, 360448
  s_cselect_b32 s58, 0, s58
  s_waitcnt vmcnt(7)
  ds_read_b64_tr_b16 v[192:193], v46 offset:4096
  ds_read_b64_tr_b16 v[194:195], v46 offset:4608
  ds_read_b64_tr_b16 v[196:197], v47 offset:4096
  ds_read_b64_tr_b16 v[198:199], v47 offset:4608
  s_add_u32 s14, s19, 16384
  buffer_load_dword v12, v15, s[40:43], s14 offen sc1
  s_waitcnt lgkmcnt(12)
  s_add_u32 s12, s69, s58
  s_add_u32 m0, s57, 12288
  s_nop 0
  buffer_load_dwordx4 v44, s[48:51], s12 offen lds
  s_add_u32 m0, m0, 1024
  s_nop 0
  buffer_load_dwordx4 v45, s[48:51], s12 offen lds
  s_add_u32 s58, s58, 0x4000
  s_cmp_eq_u32 s58, 360448
  s_cselect_b32 s58, 0, s58
  s_waitcnt vmcnt(8)
  ds_read_b64_tr_b16 v[200:201], v46 offset:6144
  ds_read_b64_tr_b16 v[202:203], v46 offset:6656
  ds_read_b64_tr_b16 v[204:205], v47 offset:6144
  ds_read_b64_tr_b16 v[206:207], v47 offset:6656
  s_waitcnt lgkmcnt(12)
  s_add_u32 s12, s69, s58
  s_add_u32 m0, s57, 14336
  s_nop 0
  buffer_load_dwordx4 v44, s[48:51], s12 offen lds
  s_add_u32 m0, m0, 1024
  s_nop 0
  buffer_load_dwordx4 v45, s[48:51], s12 offen lds
  s_add_u32 s58, s58, 0x4000
  s_cmp_eq_u32 s58, 360448
  s_cselect_b32 s58, 0, s58
  s_waitcnt vmcnt(8)
  ds_read_b64_tr_b16 v[208:209], v46 offset:8192
  ds_read_b64_tr_b16 v[210:211], v46 offset:8704
  ds_read_b64_tr_b16 v[212:213], v47 offset:8192
  ds_read_b64_tr_b16 v[214:215], v47 offset:8704
  s_waitcnt lgkmcnt(12)
  s_add_u32 s12, s69, s58
  s_add_u32 m0, s57, 16384
  s_nop 0
  buffer_load_dwordx4 v44, s[48:51], s12 offen lds
  s_add_u32 m0, m0, 1024
  s_nop 0
  buffer_load_dwordx4 v45, s[48:51], s12 offen lds
  s_add_u32 s58, s58, 0x4000
  s_cmp_eq_u32 s58, 360448
  s_cselect_b32 s58, 0, s58
  s_waitcnt vmcnt(7)
  ds_read_b64_tr_b16 v[216:217], v46 offset:10240
  ds_read_b64_tr_b16 v[218:219], v46 offset:10752
  ds_read_b64_tr_b16 v[220:221], v47 offset:10240
  ds_read_b64_tr_b16 v[222:223], v47 offset:10752
SK_78:
  v_xor_b32 v37, v7, v37
  v_xor_b32 v39, v7, v39
  v_or_b32 v37, v37, v39
  v_cmp_ne_u32 vcc, 0, v37
  s_cbranch_vccnz SC_77
SD_79:
  v_add_f32 v36, v36, v36 row_ror:8
  v_add_f32 v38, v38, v38 row_ror:8
  s_nop 1
  v_permlane16_swap_b32 v36, v38
  v_add_f32 v36, v36, v38
  v_mov_b32 v39, v36
  s_nop 1
  v_permlane32_swap_b32 v36, v39
  v_add_f32 v36, v36, v39
  v_mov_b32 v38, v36
  s_nop 1
  v_permlane16_swap_b32 v36, v38
  v_mul_f32 v36, s61, v36
  v_mul_f32 v38, s61, v38
  v_fma_f32 v38, -v36, v36, v38
  v_max_f32 v38, 0, v38
  v_add_f32 v38, s62, v38
  v_rsq_f32 v8, v38
  s_waitcnt lgkmcnt(12)
  s_add_u32 s12, s69, s58
  s_add_u32 m0, s57, 18432
  s_nop 0
  buffer_load_dwordx4 v44, s[48:51], s12 offen lds
  s_add_u32 m0, m0, 1024
  s_nop 0
  buffer_load_dwordx4 v45, s[48:51], s12 offen lds
  ds_read_b32 v40, v5 offset:16
  s_waitcnt lgkmcnt(0)
SK_81:
  v_cmp_gt_u32 vcc, 8, v40
  s_cbranch_vccnz SC_80
SD_82:
  s_waitcnt vmcnt(8)
  v_cmp_ne_u32 vcc, s9, v12
  s_add_u32 s67, s26, 0
  s_mov_b32 m0, s57
  s_cmp_eq_u64 vcc, 0
  s_cselect_b32 s59, 1, 0
  s_cselect_b32 s67, s67, 2130706432
  s_add_u32 s66, s67, s68
  s_add_u32 s56, s67, 22528
  buffer_load_dword v12, v15, s[40:43], s14 offen sc1
  buffer_load_dwordx4 v9, s[40:43], s66 offen sc1 lds
  s_add_u32 m0, m0, 1024
  s_add_u32 s66, s66, 1024
  s_cmp_eq_u32 s66, s56
  s_cselect_b32 s66, s67, s66
  buffer_load_dwordx4 v9, s[40:43], s66 offen sc1 lds
  s_add_u32 m0, m0, 1024
  s_add_u32 s66, s66, 1024
  s_cmp_eq_u32 s66, s56
  s_cselect_b32 s66, s67, s66
  s_waitcnt vmcnt(8)
  ds_read_b64_tr_b16 v[224:225], v46 offset:12288
  ds_read_b64_tr_b16 v[226:227], v46 offset:12800
  ds_read_b64_tr_b16 v[228:229], v47 offset:12288
  ds_read_b64_tr_b16 v[230:231], v47 offset:12800
  buffer_load_dwordx4 v9, s[40:43], s66 offen sc1 lds
  s_add_u32 m0, m0, 1024
  s_add_u32 s66, s66, 1024
  s_cmp_eq_u32 s66, s56
  s_cselect_b32 s66, s67, s66
  buffer_load_dwordx4 v9, s[40:43], s66 offen sc1 lds
  s_add_u32 m0, m0, 1024
  s_add_u32 s66, s66, 1024
  s_cmp_eq_u32 s66, s56
  s_cselect_b32 s66, s67, s66
  s_waitcnt vmcnt(8)
  ds_read_b64_tr_b16 v[232:233], v46 offset:14336
  ds_read_b64_tr_b16 v[234:235], v46 offset:14848
  ds_read_b64_tr_b16 v[236:237], v47 offset:14336
  ds_read_b64_tr_b16 v[238:239], v47 offset:14848
  s_waitcnt lgkmcnt(4)
  buffer_load_dwordx4 v9, s[40:43], s66 offen sc1 lds
  s_add_u32 m0, m0, 1024
  s_add_u32 s66, s66, 1024
  s_cmp_eq_u32 s66, s56
  s_cselect_b32 s66, s67, s66
  buffer_load_dwordx4 v9, s[40:43], s66 offen sc1 lds
  s_add_u32 m0, m0, 1024
  s_add_u32 s66, s66, 1024
  s_cmp_eq_u32 s66, s56
  s_cselect_b32 s66, s67, s66
  s_waitcnt vmcnt(8)
  ds_read_b64_tr_b16 v[240:241], v46 offset:16384
  ds_read_b64_tr_b16 v[242:243], v46 offset:16896
  ds_read_b64_tr_b16 v[244:245], v47 offset:16384
  ds_read_b64_tr_b16 v[246:247], v47 offset:16896
  s_waitcnt lgkmcnt(4)
  buffer_load_dwordx4 v9, s[40:43], s66 offen sc1 lds
  s_add_u32 m0, m0, 1024
  s_add_u32 s66, s66, 1024
  s_cmp_eq_u32 s66, s56
  s_cselect_b32 s66, s67, s66
  buffer_load_dwordx4 v9, s[40:43], s66 offen sc1 lds
  s_add_u32 m0, m0, 1024
  s_add_u32 s66, s66, 1024
  s_cmp_eq_u32 s66, s56
  s_cselect_b32 s66, s67, s66
  s_waitcnt vmcnt(8)
  ds_read_b64_tr_b16 v[248:249], v46 offset:18432
  ds_read_b64_tr_b16 v[250:251], v46 offset:18944
  ds_read_b64_tr_b16 v[252:253], v47 offset:18432
  ds_read_b64_tr_b16 v[254:255], v47 offset:18944
  s_waitcnt lgkmcnt(0)
  s_cmp_eq_u32 s59, 1
  s_cbranch_scc1 HPRE_83
  s_add_u32 s67, s26, 0
  s_mov_b32 m0, s57
  s_add_u32 s66, s67, s68
  s_add_u32 s56, s67, 22528
  s_waitcnt vmcnt(0)
SK_85:
  v_cmp_ne_u32 vcc, s9, v12
  s_cbranch_vccnz SC_84
SD_86:
  buffer_load_dwordx4 v9, s[40:43], s66 offen sc1 lds
  s_add_u32 m0, m0, 1024
  s_add_u32 s66, s66, 1024
  s_cmp_eq_u32 s66, s56
  s_cselect_b32 s66, s67, s66
  buffer_load_dwordx4 v9, s[40:43], s66 offen sc1 lds
  s_add_u32 m0, m0, 1024
  s_add_u32 s66, s66, 1024
  s_cmp_eq_u32 s66, s56
  s_cselect_b32 s66, s67, s66
  buffer_load_dwordx4 v9, s[40:43], s66 offen sc1 lds
  s_add_u32 m0, m0, 1024
  s_add_u32 s66, s66, 1024
  s_cmp_eq_u32 s66, s56
  s_cselect_b32 s66, s67, s66
  buffer_load_dwordx4 v9, s[40:43], s66 offen sc1 lds
  s_add_u32 m0, m0, 1024
  s_add_u32 s66, s66, 1024
  s_cmp_eq_u32 s66, s56
  s_cselect_b32 s66, s67, s66
  buffer_load_dwordx4 v9, s[40:43], s66 offen sc1 lds
  s_add_u32 m0, m0, 1024
  s_add_u32 s66, s66, 1024
  s_cmp_eq_u32 s66, s56
  s_cselect_b32 s66, s67, s66
  buffer_load_dwordx4 v9, s[40:43], s66 offen sc1 lds
  s_add_u32 m0, m0, 1024
  s_add_u32 s66, s66, 1024
  s_cmp_eq_u32 s66, s56
  s_cselect_b32 s66, s67, s66
  buffer_load_dwordx4 v9, s[40:43], s66 offen sc1 lds
  s_add_u32 m0, m0, 1024
  s_add_u32 s66, s66, 1024
  s_cmp_eq_u32 s66, s56
  s_cselect_b32 s66, s67, s66
  buffer_load_dwordx4 v9, s[40:43], s66 offen sc1 lds
  s_add_u32 m0, m0, 1024
  s_add_u32 s66, s66, 1024
  s_cmp_eq_u32 s66, s56
  s_cselect_b32 s66, s67, s66
HPRE_83:
  s_setprio 1
  s_waitcnt vmcnt(7)
  ds_read_b128 v[28:31], v19 offset:0
  buffer_load_dwordx4 v9, s[40:43], s66 offen sc1 lds
  s_add_u32 m0, m0, 1024
  s_add_u32 s66, s66, 1024
  s_cmp_eq_u32 s66, s56
  s_cselect_b32 s66, s67, s66
  s_waitcnt vmcnt(7)
  ds_read_b128 v[32:35], v19 offset:1024
  buffer_load_dwordx4 v9, s[40:43], s66 offen sc1 lds
  s_add_u32 m0, m0, 1024
  s_add_u32 s66, s66, 1024
  s_cmp_eq_u32 s66, s56
  s_cselect_b32 s66, s67, s66
  s_waitcnt lgkmcnt(1)
  v_mfma_f32_32x32x16_bf16 v[48:63], v[80:83], v[28:31], 0
  buffer_load_dwordx4 v9, s[40:43], s66 offen sc1 lds
  s_add_u32 m0, m0, 1024
  s_add_u32 s66, s66, 1024
  s_cmp_eq_u32 s66, s56
  s_cselect_b32 s66, s67, s66
  v_mfma_f32_32x32x16_bf16 v[64:79], v[84:87], v[28:31], 0
  s_waitcnt vmcnt(8)
  ds_read_b128 v[36:39], v19 offset:2048
  s_waitcnt lgkmcnt(1)
  v_mfma_f32_32x32x16_bf16 v[48:63], v[88:91], v[32:35], v[48:63]
  buffer_load_dwordx4 v9, s[40:43], s66 offen sc1 lds
  s_add_u32 m0, m0, 1024
  s_add_u32 s66, s66, 1024
  s_cmp_eq_u32 s66, s56
  s_cselect_b32 s66, s67, s66
  v_mfma_f32_32x32x16_bf16 v[64:79], v[92:95], v[32:35], v[64:79]
  s_waitcnt vmcnt(8)
  ds_read_b128 v[40:43], v19 offset:3072
  s_waitcnt lgkmcnt(1)
  v_mfma_f32_32x32x16_bf16 v[48:63], v[96:99], v[36:39], v[48:63]
  buffer_load_dwordx4 v9, s[40:43], s66 offen sc1 lds
  s_add_u32 m0, m0, 1024
  s_add_u32 s66, s66, 1024
  s_cmp_eq_u32 s66, s56
  s_cselect_b32 s66, s67, s66
  v_mfma_f32_32x32x16_bf16 v[64:79], v[100:103], v[36:39], v[64:79]
  s_waitcnt vmcnt(8)
  ds_read_b128 v[44:47], v19 offset:4096
  s_waitcnt lgkmcnt(1)
  v_mfma_f32_32x32x16_bf16 v[48:63], v[104:107], v[40:43], v[48:63]
  buffer_load_dwordx4 v9, s[40:43], s66 offen sc1 lds
  s_add_u32 m0, m0, 1024
  s_add_u32 s66, s66, 1024
  s_cmp_eq_u32 s66, s56
  s_cselect_b32 s66, s67, s66
  v_mfma_f32_32x32x16_bf16 v[64:79], v[108:111], v[40:43], v[64:79]
  s_waitcnt vmcnt(8)
  ds_read_b128 v[28:31], v19 offset:5120
  s_waitcnt lgkmcnt(1)
  v_mfma_f32_32x32x16_bf16 v[48:63], v[112:115], v[44:47], v[48:63]
  buffer_load_dwordx4 v9, s[40:43], s66 offen sc1 lds
  s_add_u32 m0, m0, 1024
  s_add_u32 s66, s66, 1024
  s_cmp_eq_u32 s66, s56
  s_cselect_b32 s66, s67, s66
  v_mfma_f32_32x32x16_bf16 v[64:79], v[116:119], v[44:47], v[64:79]
  s_waitcnt vmcnt(8)
  ds_read_b128 v[32:35], v19 offset:6144
  s_waitcnt lgkmcnt(1)
  v_mfma_f32_32x32x16_bf16 v[48:63], v[120:123], v[28:31], v[48:63]
  buffer_load_dwordx4 v9, s[40:43], s66 offen sc1 lds
  s_add_u32 m0, m0, 1024
  s_add_u32 s66, s66, 1024
  s_cmp_eq_u32 s66, s56
  s_cselect_b32 s66, s67, s66
  v_mfma_f32_32x32x16_bf16 v[64:79], v[124:127], v[28:31], v[64:79]
  s_waitcnt vmcnt(8)
  ds_read_b128 v[36:39], v19 offset:7168
  s_waitcnt lgkmcnt(1)
  v_mfma_f32_32x32x16_bf16 v[48:63], v[128:131], v[32:35], v[48:63]
  buffer_load_dwordx4 v9, s[40:43], s66 offen sc1 lds
  s_add_u32 m0, m0, 1024
  s_add_u32 s66, s66, 1024
  s_cmp_eq_u32 s66, s56
  s_cselect_b32 s66, s67, s66
  v_mfma_f32_32x32x16_bf16 v[64:79], v[132:135], v[32:35], v[64:79]
  s_waitcnt vmcnt(8)
  ds_read_b128 v[40:43], v19 offset:8192
  s_waitcnt lgkmcnt(1)
  v_mfma_f32_32x32x16_bf16 v[48:63], v[136:139], v[36:39], v[48:63]
  buffer_load_dwordx4 v9, s[40:43], s66 offen sc1 lds
  s_add_u32 m0, m0, 1024
  s_add_u32 s66, s66, 1024
  s_cmp_eq_u32 s66, s56
  s_cselect_b32 s66, s67, s66
  v_mfma_f32_32x32x16_bf16 v[64:79], v[140:143], v[36:39], v[64:79]
  s_waitcnt vmcnt(8)
  ds_read_b128 v[44:47], v19 offset:9216
  s_waitcnt lgkmcnt(1)
  v_mfma_f32_32x32x16_bf16 v[48:63], v[144:147], v[40:43], v[48:63]
  buffer_load_dwordx4 v9, s[40:43], s66 offen sc1 lds
  s_add_u32 m0, m0, 1024
  s_add_u32 s66, s66, 1024
  s_cmp_eq_u32 s66, s56
  s_cselect_b32 s66, s67, s66
  v_mfma_f32_32x32x16_bf16 v[64:79], v[148:151], v[40:43], v[64:79]
  s_waitcnt vmcnt(8)
  ds_read_b128 v[28:31], v19 offset:10240
  s_waitcnt lgkmcnt(1)
  v_mfma_f32_32x32x16_bf16 v[48:63], v[152:155], v[44:47], v[48:63]
  buffer_load_dwordx4 v9, s[40:43], s66 offen sc1 lds
  s_add_u32 m0, m0, 1024
  s_add_u32 s66, s66, 1024
  s_cmp_eq_u32 s66, s56
  s_cselect_b32 s66, s67, s66
  v_mfma_f32_32x32x16_bf16 v[64:79], v[156:159], v[44:47], v[64:79]
  s_waitcnt vmcnt(8)
  ds_read_b128 v[32:35], v19 offset:11264
  s_waitcnt lgkmcnt(1)
  v_mfma_f32_32x32x16_bf16 v[48:63], v[160:163], v[28:31], v[48:63]
  buffer_load_dwordx4 v9, s[40:43], s66 offen sc1 lds
  s_add_u32 m0, m0, 1024
  s_add_u32 s66, s66, 1024
  s_cmp_eq_u32 s66, s56
  s_cselect_b32 s66, s67, s66
  v_mfma_f32_32x32x16_bf16 v[64:79], v[164:167], v[28:31], v[64:79]
  s_waitcnt vmcnt(8)
  ds_read_b128 v[36:39], v19 offset:12288
  s_waitcnt lgkmcnt(1)
  v_mfma_f32_32x32x16_bf16 v[48:63], v[168:171], v[32:35], v[48:63]
  buffer_load_dwordx4 v9, s[40:43], s66 offen sc1 lds
  v_mfma_f32_32x32x16_bf16 v[64:79], v[172:175], v[32:35], v[64:79]
  s_waitcnt vmcnt(8)
  ds_read_b128 v[40:43], v19 offset:13312
  ds_read_b32 v3, v5 offset:48
  s_waitcnt lgkmcnt(2)
  v_mfma_f32_32x32x16_bf16 v[48:63], v[176:179], v[36:39], v[48:63]
  v_mfma_f32_32x32x16_bf16 v[64:79], v[180:183], v[36:39], v[64:79]
  s_waitcnt vmcnt(7)
  ds_read_b128 v[44:47], v19 offset:14336
  s_waitcnt vmcnt(6)
  ds_read_b128 v[28:31], v19 offset:15360
  s_waitcnt lgkmcnt(3)
  v_mfma_f32_32x32x16_bf16 v[48:63], v[184:187], v[40:43], v[48:63]
  v_mfma_f32_32x32x16_bf16 v[64:79], v[188:191], v[40:43], v[64:79]
  s_waitcnt vmcnt(5)
  ds_read_b128 v[32:35], v19 offset:16384
  s_waitcnt lgkmcnt(2)
  v_mfma_f32_32x32x16_bf16 v[48:63], v[192:195], v[44:47], v[48:63]
  s_waitcnt vmcnt(4)
  ds_read_b128 v[36:39], v19 offset:17408
  s_waitcnt lgkmcnt(2)
  v_mfma_f32_32x32x16_bf16 v[48:63], v[200:203], v[28:31], v[48:63]
  s_waitcnt vmcnt(3)
  ds_read_b128 v[40:43], v19 offset:18432
  s_waitcnt lgkmcnt(2)
  v_mfma_f32_32x32x16_bf16 v[48:63], v[208:211], v[32:35], v[48:63]
  s_waitcnt vmcnt(2)
  ds_read_b128 v[44:47], v19 offset:19456
  s_waitcnt lgkmcnt(2)
  v_mfma_f32_32x32x16_bf16 v[48:63], v[216:219], v[36:39], v[48:63]
  s_waitcnt vmcnt(1)
  ds_read_b128 v[28:31], v19 offset:20480
  s_waitcnt lgkmcnt(2)
  v_mfma_f32_32x32x16_bf16 v[48:63], v[224:227], v[40:43], v[48:63]
  s_waitcnt vmcnt(0)
  ds_read_b128 v[32:35], v19 offset:21504
  s_waitcnt lgkmcnt(2)
  v_mfma_f32_32x32x16_bf16 v[48:63], v[232:235], v[44:47], v[48:63]
  ds_read_b128 v[36:39], v19 offset:14336
  s_waitcnt lgkmcnt(2)
  v_mfma_f32_32x32x16_bf16 v[48:63], v[240:243], v[28:31], v[48:63]
  s_add_u32 s14, s19, 32768
  buffer_load_dword v12, v15, s[40:43], s14 offen sc1
  ds_read_b128 v[40:43], v19 offset:15360
  s_waitcnt lgkmcnt(2)
  v_mfma_f32_32x32x16_bf16 v[48:63], v[248:251], v[32:35], v[48:63]
  ds_read_b128 v[44:47], v19 offset:16384
  s_waitcnt lgkmcnt(2)
  v_mfma_f32_32x32x16_bf16 v[64:79], v[196:199], v[36:39], v[64:79]
  ds_read_b128 v[28:31], v19 offset:17408
SK_88:
  v_cmp_gt_u32 vcc, 4, v3
  s_cbranch_vccnz SC_87
SD_89:
  s_waitcnt lgkmcnt(2)
  v_mfma_f32_32x32x16_bf16 v[64:79], v[204:207], v[40:43], v[64:79]
  ds_read_b128 v[32:35], v19 offset:18432
  v_xor_b32 v1, 0, v13
  s_nop 1
  ds_write_b128 v1, v[48:51] offset:0
  s_waitcnt lgkmcnt(3)
  v_mfma_f32_32x32x16_bf16 v[64:79], v[212:215], v[44:47], v[64:79]
  ds_read_b128 v[36:39], v19 offset:19456
  v_xor_b32 v2, 16, v13
  ds_write_b128 v2, v[52:55] offset:0
  s_waitcnt lgkmcnt(4)
  v_mfma_f32_32x32x16_bf16 v[64:79], v[220:223], v[28:31], v[64:79]
  ds_read_b128 v[40:43], v19 offset:20480
  v_xor_b32 v1, 160, v13
  ds_write_b128 v1, v[56:59] offset:0
  s_waitcnt lgkmcnt(5)
  v_mfma_f32_32x32x16_bf16 v[64:79], v[228:231], v[32:35], v[64:79]
  ds_read_b128 v[44:47], v19 offset:21504
  v_xor_b32 v2, 176, v13
  ds_write_b128 v2, v[60:63] offset:0
  s_waitcnt lgkmcnt(5)
  v_mfma_f32_32x32x16_bf16 v[64:79], v[236:239], v[36:39], v[64:79]
  s_waitcnt lgkmcnt(3)
  v_mfma_f32_32x32x16_bf16 v[64:79], v[244:247], v[40:43], v[64:79]
  s_waitcnt vmcnt(0)
  v_cmp_ne_u32 vcc, s9, v12
  s_add_u32 s67, s26, 2883584
  s_mov_b32 m0, s57
  s_cmp_eq_u64 vcc, 0
  s_cselect_b32 s59, 1, 0
  s_cselect_b32 s67, s67, 2130706432
  s_add_u32 s66, s67, s68
  s_add_u32 s56, s67, 22528
  buffer_load_dwordx4 v9, s[40:43], s66 offen sc1 lds
  s_add_u32 m0, m0, 1024
  s_add_u32 s66, s66, 1024
  s_cmp_eq_u32 s66, s56
  s_cselect_b32 s66, s67, s66
  s_waitcnt lgkmcnt(1)
  v_mfma_f32_32x32x16_bf16 v[64:79], v[252:255], v[44:47], v[64:79]
  buffer_load_dwordx4 v9, s[40:43], s66 offen sc1 lds
  s_add_u32 m0, m0, 1024
  s_add_u32 s66, s66, 1024
  s_cmp_eq_u32 s66, s56
  s_cselect_b32 s66, s67, s66
  v_xor_b32 v1, 64, v13
  s_nop 5
  ds_write_b128 v1, v[64:67] offset:0
  buffer_load_dwordx4 v9, s[40:43], s66 offen sc1 lds
  s_add_u32 m0, m0, 1024
  s_add_u32 s66, s66, 1024
  s_cmp_eq_u32 s66, s56
  s_cselect_b32 s66, s67, s66
  v_xor_b32 v2, 80, v13
  ds_write_b128 v2, v[68:71] offset:0
  buffer_load_dwordx4 v9, s[40:43], s66 offen sc1 lds
  s_add_u32 m0, m0, 1024
  s_add_u32 s66, s66, 1024
  s_cmp_eq_u32 s66, s56
  s_cselect_b32 s66, s67, s66
  v_xor_b32 v1, 224, v13
  ds_write_b128 v1, v[72:75] offset:0
  buffer_load_dwordx4 v9, s[40:43], s66 offen sc1 lds
  s_add_u32 m0, m0, 1024
  s_add_u32 s66, s66, 1024
  s_cmp_eq_u32 s66, s56
  s_cselect_b32 s66, s67, s66
  v_xor_b32 v2, 240, v13
  ds_write_b128 v2, v[76:79] offset:0
  buffer_load_dwordx4 v9, s[40:43], s66 offen sc1 lds
  s_add_u32 m0, m0, 1024
  s_add_u32 s66, s66, 1024
  s_cmp_eq_u32 s66, s56
  s_cselect_b32 s66, s67, s66
  s_mov_b64 exec, 1
  ds_add_u32 v5, v6 offset:64
  s_mov_b64 exec, -1
  s_setprio 0
  buffer_load_dword v12, v15, s[40:43], s14 offen sc1
  s_cmp_eq_u32 s59, 1
  s_cbranch_scc1 HPRE_90
  s_add_u32 s67, s26, 2883584
  s_mov_b32 m0, s57
  s_add_u32 s66, s67, s68
  s_add_u32 s56, s67, 22528
  s_waitcnt vmcnt(0)
SK_92:
  v_cmp_ne_u32 vcc, s9, v12
  s_cbranch_vccnz SC_91
SD_93:
  buffer_load_dwordx4 v9, s[40:43], s66 offen sc1 lds
  s_add_u32 m0, m0, 1024
  s_add_u32 s66, s66, 1024
  s_cmp_eq_u32 s66, s56
  s_cselect_b32 s66, s67, s66
  buffer_load_dwordx4 v9, s[40:43], s66 offen sc1 lds
  s_add_u32 m0, m0, 1024
  s_add_u32 s66, s66, 1024
  s_cmp_eq_u32 s66, s56
  s_cselect_b32 s66, s67, s66
  buffer_load_dwordx4 v9, s[40:43], s66 offen sc1 lds
  s_add_u32 m0, m0, 1024
  s_add_u32 s66, s66, 1024
  s_cmp_eq_u32 s66, s56
  s_cselect_b32 s66, s67, s66
  buffer_load_dwordx4 v9, s[40:43], s66 offen sc1 lds
  s_add_u32 m0, m0, 1024
  s_add_u32 s66, s66, 1024
  s_cmp_eq_u32 s66, s56
  s_cselect_b32 s66, s67, s66
  buffer_load_dwordx4 v9, s[40:43], s66 offen sc1 lds
  s_add_u32 m0, m0, 1024
  s_add_u32 s66, s66, 1024
  s_cmp_eq_u32 s66, s56
  s_cselect_b32 s66, s67, s66
  buffer_load_dwordx4 v9, s[40:43], s66 offen sc1 lds
  s_add_u32 m0, m0, 1024
  s_add_u32 s66, s66, 1024
  s_cmp_eq_u32 s66, s56
  s_cselect_b32 s66, s67, s66
HPRE_90:
  s_setprio 1
  s_waitcnt vmcnt(5)
  ds_read_b128 v[28:31], v19 offset:0
  buffer_load_dwordx4 v9, s[40:43], s66 offen sc1 lds
  s_add_u32 m0, m0, 1024
  s_add_u32 s66, s66, 1024
  s_cmp_eq_u32 s66, s56
  s_cselect_b32 s66, s67, s66
  s_waitcnt vmcnt(5)
  ds_read_b128 v[32:35], v19 offset:1024
  buffer_load_dwordx4 v9, s[40:43], s66 offen sc1 lds
  s_add_u32 m0, m0, 1024
  s_add_u32 s66, s66, 1024
  s_cmp_eq_u32 s66, s56
  s_cselect_b32 s66, s67, s66
  s_waitcnt lgkmcnt(1)
  v_mfma_f32_32x32x16_bf16 v[48:63], v[80:83], v[28:31], 0
  buffer_load_dwordx4 v9, s[40:43], s66 offen sc1 lds
  s_add_u32 m0, m0, 1024
  s_add_u32 s66, s66, 1024
  s_cmp_eq_u32 s66, s56
  s_cselect_b32 s66, s67, s66
  buffer_load_dwordx4 v9, s[40:43], s66 offen sc1 lds
  s_add_u32 m0, m0, 1024
  s_add_u32 s66, s66, 1024
  s_cmp_eq_u32 s66, s56
  s_cselect_b32 s66, s67, s66
  v_mfma_f32_32x32x16_bf16 v[64:79], v[84:87], v[28:31], 0
  s_waitcnt vmcnt(7)
  ds_read_b128 v[36:39], v19 offset:2048
  s_waitcnt lgkmcnt(1)
  v_mfma_f32_32x32x16_bf16 v[48:63], v[88:91], v[32:35], v[48:63]
  buffer_load_dwordx4 v9, s[40:43], s66 offen sc1 lds
  s_add_u32 m0, m0, 1024
  s_add_u32 s66, s66, 1024
  s_cmp_eq_u32 s66, s56
  s_cselect_b32 s66, s67, s66
  v_mfma_f32_32x32x16_bf16 v[64:79], v[92:95], v[32:35], v[64:79]
  s_waitcnt vmcnt(7)
  ds_read_b128 v[40:43], v19 offset:3072
  s_waitcnt lgkmcnt(1)
  v_mfma_f32_32x32x16_bf16 v[48:63], v[96:99], v[36:39], v[48:63]
  buffer_load_dwordx4 v9, s[40:43], s66 offen sc1 lds
  s_add_u32 m0, m0, 1024
  s_add_u32 s66, s66, 1024
  s_cmp_eq_u32 s66, s56
  s_cselect_b32 s66, s67, s66
  v_mfma_f32_32x32x16_bf16 v[64:79], v[100:103], v[36:39], v[64:79]
  s_waitcnt vmcnt(7)
  ds_read_b128 v[44:47], v19 offset:4096
  s_waitcnt lgkmcnt(1)
  v_mfma_f32_32x32x16_bf16 v[48:63], v[104:107], v[40:43], v[48:63]
  buffer_load_dwordx4 v9, s[40:43], s66 offen sc1 lds
  s_add_u32 m0, m0, 1024
  s_add_u32 s66, s66, 1024
  s_cmp_eq_u32 s66, s56
  s_cselect_b32 s66, s67, s66
  v_mfma_f32_32x32x16_bf16 v[64:79], v[108:111], v[40:43], v[64:79]
  s_waitcnt vmcnt(7)
  ds_read_b128 v[28:31], v19 offset:5120
  s_waitcnt lgkmcnt(1)
  v_mfma_f32_32x32x16_bf16 v[48:63], v[112:115], v[44:47], v[48:63]
  buffer_load_dwordx4 v9, s[40:43], s66 offen sc1 lds
  s_add_u32 m0, m0, 1024
  s_add_u32 s66, s66, 1024
  s_cmp_eq_u32 s66, s56
  s_cselect_b32 s66, s67, s66
  v_mfma_f32_32x32x16_bf16 v[64:79], v[116:119], v[44:47], v[64:79]
  s_waitcnt vmcnt(7)
  ds_read_b128 v[32:35], v19 offset:6144
  s_waitcnt lgkmcnt(1)
  v_mfma_f32_32x32x16_bf16 v[48:63], v[120:123], v[28:31], v[48:63]
  buffer_load_dwordx4 v9, s[40:43], s66 offen sc1 lds
  s_add_u32 m0, m0, 1024
  s_add_u32 s66, s66, 1024
  s_cmp_eq_u32 s66, s56
  s_cselect_b32 s66, s67, s66
  v_mfma_f32_32x32x16_bf16 v[64:79], v[124:127], v[28:31], v[64:79]
  s_waitcnt vmcnt(7)
  ds_read_b128 v[36:39], v19 offset:7168
  s_waitcnt lgkmcnt(1)
  v_mfma_f32_32x32x16_bf16 v[48:63], v[128:131], v[32:35], v[48:63]
  buffer_load_dwordx4 v9, s[40:43], s66 offen sc1 lds
  s_add_u32 m0, m0, 1024
  s_add_u32 s66, s66, 1024
  s_cmp_eq_u32 s66, s56
  s_cselect_b32 s66, s67, s66
  v_mfma_f32_32x32x16_bf16 v[64:79], v[132:135], v[32:35], v[64:79]
  s_waitcnt vmcnt(7)
  ds_read_b128 v[40:43], v19 offset:8192
  s_waitcnt lgkmcnt(1)
  v_mfma_f32_32x32x16_bf16 v[48:63], v[136:139], v[36:39], v[48:63]
  buffer_load_dwordx4 v9, s[40:43], s66 offen sc1 lds
  s_add_u32 m0, m0, 1024
  s_add_u32 s66, s66, 1024
  s_cmp_eq_u32 s66, s56
  s_cselect_b32 s66, s67, s66
  v_mfma_f32_32x32x16_bf16 v[64:79], v[140:143], v[36:39], v[64:79]
  s_waitcnt vmcnt(7)
  ds_read_b128 v[44:47], v19 offset:9216
  s_waitcnt lgkmcnt(1)
  v_mfma_f32_32x32x16_bf16 v[48:63], v[144:147], v[40:43], v[48:63]
  buffer_load_dwordx4 v9, s[40:43], s66 offen sc1 lds
  s_add_u32 m0, m0, 1024
  s_add_u32 s66, s66, 1024
  s_cmp_eq_u32 s66, s56
  s_cselect_b32 s66, s67, s66
  v_mfma_f32_32x32x16_bf16 v[64:79], v[148:151], v[40:43], v[64:79]
  s_waitcnt vmcnt(7)
  ds_read_b128 v[28:31], v19 offset:10240
  s_waitcnt lgkmcnt(1)
  v_mfma_f32_32x32x16_bf16 v[48:63], v[152:155], v[44:47], v[48:63]
  buffer_load_dwordx4 v9, s[40:43], s66 offen sc1 lds
  s_add_u32 m0, m0, 1024
  s_add_u32 s66, s66, 1024
  s_cmp_eq_u32 s66, s56
  s_cselect_b32 s66, s67, s66
  v_mfma_f32_32x32x16_bf16 v[64:79], v[156:159], v[44:47], v[64:79]
  s_waitcnt vmcnt(7)
  ds_read_b128 v[32:35], v19 offset:11264
  s_waitcnt lgkmcnt(1)
  v_mfma_f32_32x32x16_bf16 v[48:63], v[160:163], v[28:31], v[48:63]
  buffer_load_dwordx4 v9, s[40:43], s66 offen sc1 lds
  s_add_u32 m0, m0, 1024
  s_add_u32 s66, s66, 1024
  s_cmp_eq_u32 s66, s56
  s_cselect_b32 s66, s67, s66
  v_mfma_f32_32x32x16_bf16 v[64:79], v[164:167], v[28:31], v[64:79]
  s_waitcnt vmcnt(7)
  ds_read_b128 v[36:39], v19 offset:12288
  s_waitcnt lgkmcnt(1)
  v_mfma_f32_32x32x16_bf16 v[48:63], v[168:171], v[32:35], v[48:63]
  buffer_load_dwordx4 v9, s[40:43], s66 offen sc1 lds
  s_add_u32 m0, m0, 1024
  s_add_u32 s66, s66, 1024
  s_cmp_eq_u32 s66, s56
  s_cselect_b32 s66, s67, s66
  v_mfma_f32_32x32x16_bf16 v[64:79], v[172:175], v[32:35], v[64:79]
  s_waitcnt vmcnt(7)
  ds_read_b128 v[40:43], v19 offset:13312
  ds_read_b32 v3, v5 offset:52
  s_waitcnt lgkmcnt(2)
  v_mfma_f32_32x32x16_bf16 v[48:63], v[176:179], v[36:39], v[48:63]
  buffer_load_dwordx4 v9, s[40:43], s66 offen sc1 lds
  v_mfma_f32_32x32x16_bf16 v[64:79], v[180:183], v[36:39], v[64:79]
  s_waitcnt vmcnt(7)
  ds_read_b128 v[44:47], v19 offset:14336
  s_waitcnt vmcnt(6)
  ds_read_b128 v[28:31], v19 offset:15360
  s_waitcnt lgkmcnt(3)
  v_mfma_f32_32x32x16_bf16 v[48:63], v[184:187], v[40:43], v[48:63]
  v_mfma_f32_32x32x16_bf16 v[64:79], v[188:191], v[40:43], v[64:79]
  s_waitcnt vmcnt(5)
  ds_read_b128 v[32:35], v19 offset:16384
  s_waitcnt lgkmcnt(2)
  v_mfma_f32_32x32x16_bf16 v[48:63], v[192:195], v[44:47], v[48:63]
  s_waitcnt vmcnt(4)
  ds_read_b128 v[36:39], v19 offset:17408
  s_waitcnt lgkmcnt(2)
  v_mfma_f32_32x32x16_bf16 v[48:63], v[200:203], v[28:31], v[48:63]
  s_waitcnt vmcnt(3)
  ds_read_b128 v[40:43], v19 offset:18432
  s_waitcnt lgkmcnt(2)
  v_mfma_f32_32x32x16_bf16 v[48:63], v[208:211], v[32:35], v[48:63]
  s_waitcnt vmcnt(2)
  ds_read_b128 v[44:47], v19 offset:19456
  s_waitcnt lgkmcnt(2)
  v_mfma_f32_32x32x16_bf16 v[48:63], v[216:219], v[36:39], v[48:63]
  s_waitcnt vmcnt(1)
  ds_read_b128 v[28:31], v19 offset:20480
  s_waitcnt lgkmcnt(2)
  v_mfma_f32_32x32x16_bf16 v[48:63], v[224:227], v[40:43], v[48:63]
  s_waitcnt vmcnt(0)
  ds_read_b128 v[32:35], v19 offset:21504
  s_waitcnt lgkmcnt(2)
  v_mfma_f32_32x32x16_bf16 v[48:63], v[232:235], v[44:47], v[48:63]
  ds_read_b128 v[36:39], v19 offset:14336
  s_waitcnt lgkmcnt(2)
  v_mfma_f32_32x32x16_bf16 v[48:63], v[240:243], v[28:31], v[48:63]
  ds_read_b128 v[40:43], v19 offset:15360
  s_waitcnt lgkmcnt(2)
  v_mfma_f32_32x32x16_bf16 v[48:63], v[248:251], v[32:35], v[48:63]
  ds_read_b128 v[44:47], v19 offset:16384
  s_waitcnt lgkmcnt(2)
  v_mfma_f32_32x32x16_bf16 v[64:79], v[196:199], v[36:39], v[64:79]
  ds_read_b128 v[28:31], v19 offset:17408
SK_95:
  v_cmp_gt_u32 vcc, 4, v3
  s_cbranch_vccnz SC_94
SD_96:
  s_waitcnt lgkmcnt(2)
  v_mfma_f32_32x32x16_bf16 v[64:79], v[204:207], v[40:43], v[64:79]
  ds_read_b128 v[32:35], v19 offset:18432
  v_xor_b32 v1, 0, v13
  s_nop 1
  ds_write_b128 v1, v[48:51] offset:32768
  s_waitcnt lgkmcnt(3)
  v_mfma_f32_32x32x16_bf16 v[64:79], v[212:215], v[44:47], v[64:79]
  ds_read_b128 v[36:39], v19 offset:19456
  v_xor_b32 v2, 16, v13
  ds_write_b128 v2, v[52:55] offset:32768
  s_waitcnt lgkmcnt(4)
  v_mfma_f32_32x32x16_bf16 v[64:79], v[220:223], v[28:31], v[64:79]
  ds_read_b128 v[40:43], v19 offset:20480
  v_xor_b32 v1, 160, v13
  ds_write_b128 v1, v[56:59] offset:32768
  s_waitcnt lgkmcnt(5)
  v_mfma_f32_32x32x16_bf16 v[64:79], v[228:231], v[32:35], v[64:79]
  ds_read_b128 v[44:47], v19 offset:21504
  v_xor_b32 v2, 176, v13
  ds_write_b128 v2, v[60:63] offset:32768
  s_waitcnt lgkmcnt(5)
  v_mfma_f32_32x32x16_bf16 v[64:79], v[236:239], v[36:39], v[64:79]
  s_waitcnt lgkmcnt(3)
  v_mfma_f32_32x32x16_bf16 v[64:79], v[244:247], v[40:43], v[64:79]
  s_waitcnt lgkmcnt(1)
  v_mfma_f32_32x32x16_bf16 v[64:79], v[252:255], v[44:47], v[64:79]
  v_xor_b32 v1, 64, v13
  s_nop 10
  ds_write_b128 v1, v[64:67] offset:32768
  v_xor_b32 v2, 80, v13
  ds_write_b128 v2, v[68:71] offset:32768
  v_xor_b32 v1, 224, v13
  ds_write_b128 v1, v[72:75] offset:32768
  v_xor_b32 v2, 240, v13
  ds_write_b128 v2, v[76:79] offset:32768
  s_mov_b64 exec, 1
  ds_add_u32 v5, v6 offset:68
  s_mov_b64 exec, -1
  s_setprio 3
  v_xor_b32 v37, 128, v14
  ds_read_b32 v36, v5 offset:68
  s_waitcnt lgkmcnt(0)
SK_98:
  v_cmp_gt_u32 vcc, 4, v36
  s_cbranch_vccnz SC_97
SD_99:
  ds_read_b128 v[48:51], v14 offset:0
  ds_read_b128 v[52:55], v37 offset:0
  ds_read_b128 v[56:59], v14 offset:8192
  ds_read_b128 v[60:63], v37 offset:8192
  ds_read_b128 v[64:67], v14 offset:16384
  ds_read_b128 v[68:71], v37 offset:16384
  ds_read_b128 v[72:75], v14 offset:24576
  ds_read_b128 v[76:79], v37 offset:24576
  s_mov_b64 exec, 1
  ds_add_u32 v5, v6 offset:84
  s_mov_b64 exec, -1
  s_waitcnt lgkmcnt(5)
  v_add_f32 v48, v48, v56
  v_add_f32 v49, v49, v57
  v_add_f32 v50, v50, v58
  v_add_f32 v51, v51, v59
  v_add_f32 v52, v52, v60
  v_add_f32 v53, v53, v61
  v_add_f32 v54, v54, v62
  v_add_f32 v55, v55, v63
  v_lshlrev_b32 v56, 16, v20
  v_and_b32 v57, 0xffff0000, v20
  v_lshlrev_b32 v58, 16, v21
  v_and_b32 v59, 0xffff0000, v21
  v_lshlrev_b32 v60, 16, v22
  v_and_b32 v61, 0xffff0000, v22
  v_lshlrev_b32 v62, 16, v23
  v_and_b32 v63, 0xffff0000, v23
  v_fma_f32 v56, v48, v8, v56
  v_fma_f32 v57, v49, v8, v57
  v_fma_f32 v58, v50, v8, v58
  v_fma_f32 v59, v51, v8, v59
  v_fma_f32 v60, v52, v8, v60
  v_fma_f32 v61, v53, v8, v61
  v_fma_f32 v62, v54, v8, v62
  v_fma_f32 v63, v55, v8, v63
  s_waitcnt lgkmcnt(1)
  v_add_f32 v64, v64, v72
  v_add_f32 v65, v65, v73
  v_add_f32 v66, v66, v74
  v_add_f32 v67, v67, v75
  v_add_f32 v68, v68, v76
  v_add_f32 v69, v69, v77
  v_add_f32 v70, v70, v78
  v_add_f32 v71, v71, v79
  v_fma_f32 v56, v64, v8, v56
  v_fma_f32 v57, v65, v8, v57
  v_fma_f32 v58, v66, v8, v58
  v_fma_f32 v59, v67, v8, v59
  v_fma_f32 v60, v68, v8, v60
  v_fma_f32 v61, v69, v8, v61
  v_fma_f32 v62, v70, v8, v62
  v_fma_f32 v63, v71, v8, v63
  v_add_f32 v36, v56, v57
  v_mul_f32 v38, v56, v56
  v_add_f32 v37, v58, v59
  v_mul_f32 v39, v57, v57
  v_fmac_f32 v38, v58, v58
  v_fmac_f32 v39, v59, v59
  v_fmac_f32 v38, v60, v60
  v_add_f32 v36, v36, v60
  v_fmac_f32 v39, v61, v61
  v_add_f32 v37, v37, v61
  v_fmac_f32 v38, v62, v62
  v_add_f32 v36, v36, v62
  v_fmac_f32 v39, v63, v63
  v_add_f32 v37, v37, v63
  v_add_f32 v36, v36, v37
  v_add_f32 v38, v38, v39
  s_add_u32 s11, s22, 131072
  v_xor_b32 v37, 2, v7
  v_add_f32 v36, v36, v36 row_ror:8
  v_add_f32 v38, v38, v38 row_ror:8
  s_nop 1
  v_permlane16_swap_b32 v36, v38
  v_add_f32 v36, v36, v38
  v_mov_b32 v39, v36
  s_nop 1
  v_permlane32_swap_b32 v36, v39
  v_add_f32 v36, v36, v39
  s_mov_b64 exec, 0xff00ff
  s_cmp_eq_u32 s28, 32
  s_cbranch_scc0 LC_100
  buffer_store_dwordx2 v[36:37], v16, s[40:43], s11 offen
LD_101:
  s_mov_b64 exec, -1
  v_cvt_pk_bf16_f32 v20, v56, v57
  v_cvt_pk_bf16_f32 v21, v58, v59
  v_cvt_pk_bf16_f32 v22, v60, v61
  v_cvt_pk_bf16_f32 v23, v62, v63
  s_add_u32 s13, s23, 131072
  buffer_load_dwordx4 v[36:39], v9, s[40:43], s13 offen sc1
  v_lshlrev_b32 v48, 16, v20
  v_and_b32 v49, 0xffff0000, v20
  v_lshlrev_b32 v50, 16, v21
  v_and_b32 v51, 0xffff0000, v21
  v_lshlrev_b32 v52, 16, v22
  v_and_b32 v53, 0xffff0000, v22
  v_lshlrev_b32 v54, 16, v23
  v_and_b32 v55, 0xffff0000, v23
  v_lshlrev_b32 v56, 16, v24
  v_and_b32 v57, 0xffff0000, v24
  v_lshlrev_b32 v58, 16, v25
  v_and_b32 v59, 0xffff0000, v25
  v_lshlrev_b32 v60, 16, v26
  v_and_b32 v61, 0xffff0000, v26
  v_lshlrev_b32 v62, 16, v27
  v_and_b32 v63, 0xffff0000, v27
  s_waitcnt vmcnt(0)
SK_103:
  v_xor_b32 v37, v7, v37
  v_xor_b32 v39, v7, v39
  v_xor_b32 v37, 2, v37
  v_xor_b32 v39, 2, v39
  v_or_b32 v37, v37, v39
  v_cmp_ne_u32 vcc, 0, v37
  s_cbranch_vccnz SC_102
SD_104:
  v_add_f32 v36, v36, v36 row_ror:8
  v_add_f32 v38, v38, v38 row_ror:8
  s_nop 1
  v_permlane16_swap_b32 v36, v38
  v_add_f32 v36, v36, v38
  v_mov_b32 v39, v36
  s_nop 1
  v_permlane32_swap_b32 v36, v39
  v_add_f32 v36, v36, v39
  v_mov_b32 v38, v36
  s_nop 1
  v_permlane16_swap_b32 v36, v38
  v_mul_f32 v36, s61, v36
  v_mul_f32 v38, s61, v38
  v_fma_f32 v38, -v36, v36, v38
  v_max_f32 v38, 0, v38
  v_add_f32 v38, s62, v38
  v_rsq_f32 v38, v38
  s_nop 0
  v_mul_f32 v36, -v36, v38
  v_fma_f32 v64, v48, v38, v36
  v_fma_f32 v65, v49, v38, v36
  v_fma_f32 v66, v50, v38, v36
  v_fma_f32 v67, v51, v38, v36
  v_fma_f32 v68, v52, v38, v36
  v_fma_f32 v69, v53, v38, v36
  v_fma_f32 v70, v54, v38, v36
  v_fma_f32 v71, v55, v38, v36
  v_fma_f32 v48, v64, v56, v48
  v_fma_f32 v49, v65, v57, v49
  v_fma_f32 v50, v66, v58, v50
  v_fma_f32 v51, v67, v59, v51
  v_fma_f32 v52, v68, v60, v52
  v_fma_f32 v53, v69, v61, v53
  v_fma_f32 v54, v70, v62, v54
  v_fma_f32 v55, v71, v63, v55
  v_cvt_pk_bf16_f32 v20, v48, v49
  v_cvt_pk_bf16_f32 v21, v50, v51
  v_cvt_pk_bf16_f32 v22, v52, v53
  v_cvt_pk_bf16_f32 v23, v54, v55
  s_add_u32 s11, s24, 32768
  s_cmp_eq_u32 s28, 32
  s_cbranch_scc0 LC_105
  buffer_store_dwordx4 v[20:23], v17, s[40:43], s11 offen
LD_106:
  v_add_f32 v36, v48, v49
  v_mul_f32 v38, v48, v48
  v_add_f32 v37, v50, v51
  v_mul_f32 v39, v49, v49
  v_fmac_f32 v38, v50, v50
  v_fmac_f32 v39, v51, v51
  v_fmac_f32 v38, v52, v52
  v_add_f32 v36, v36, v52
  v_fmac_f32 v39, v53, v53
  v_add_f32 v37, v37, v53
  v_fmac_f32 v38, v54, v54
  v_add_f32 v36, v36, v54
  v_fmac_f32 v39, v55, v55
  v_add_f32 v37, v37, v55
  v_add_f32 v36, v36, v37
  v_add_f32 v38, v38, v39
  s_add_u32 s11, s22, 393216
  v_xor_b32 v37, 2, v7
  v_add_f32 v36, v36, v36 row_ror:8
  v_add_f32 v38, v38, v38 row_ror:8
  s_nop 1
  v_permlane16_swap_b32 v36, v38
  v_add_f32 v36, v36, v38
  v_mov_b32 v39, v36
  s_nop 1
  v_permlane32_swap_b32 v36, v39
  v_add_f32 v36, v36, v39
  s_mov_b64 exec, 0xff00ff
  s_cmp_eq_u32 s28, 32
  s_cbranch_scc0 LC_107
  buffer_store_dwordx2 v[36:37], v16, s[40:43], s11 offen
LD_108:
  s_mov_b64 exec, -1
  s_waitcnt vmcnt(1)
  s_add_u32 s11, s18, 131072
  s_mov_b64 exec, 1
  s_cmp_eq_u32 s28, 32
  s_cbranch_scc0 LC_109
  buffer_store_dword v7, off, s[40:43], s11
LD_110:
  s_mov_b64 exec, -1
  s_add_u32 s14, s19, 131072
  s_lshl_b32 s13, s15, 13
  s_add_u32 m0, s13, 32768
  s_add_u32 s12, s21, s13
  s_add_u32 s12, s12, 32768
  ds_read_b32 v38, v5 offset:84
  s_waitcnt lgkmcnt(0)
SK_112:
  v_cmp_gt_u32 vcc, 4, v38
  s_cbranch_vccnz SC_111
SD_113:
  buffer_load_dword v36, v15, s[40:43], s14 offen sc1
  s_waitcnt vmcnt(0)
SK_115:
  v_cmp_ne_u32 vcc, s9, v36
  s_cbranch_vccnz SC_114
SD_116:
  buffer_load_dwordx4 v9, s[40:43], s12 offen offset:0 sc1 lds
  buffer_load_dwordx4 v9, s[40:43], s12 offen offset:1024 sc1 lds
  buffer_load_dwordx4 v9, s[40:43], s12 offen offset:2048 sc1 lds
  buffer_load_dwordx4 v9, s[40:43], s12 offen offset:3072 sc1 lds
  s_add_u32 s12, s12, 4096
  s_add_u32 m0, m0, 4096
  s_nop 0
  buffer_load_dwordx4 v9, s[40:43], s12 offen offset:0 sc1 lds
  buffer_load_dwordx4 v9, s[40:43], s12 offen offset:1024 sc1 lds
  buffer_load_dwordx4 v9, s[40:43], s12 offen offset:2048 sc1 lds
  buffer_load_dwordx4 v9, s[40:43], s12 offen offset:3072 sc1 lds
  s_add_u32 s13, s23, 393216
  buffer_load_dwordx4 v[36:39], v9, s[40:43], s13 offen sc1
  s_waitcnt vmcnt(0)
  s_mov_b64 exec, 1
  ds_add_u32 v5, v6 offset:44
  s_mov_b64 exec, -1
SK_118:
  v_xor_b32 v37, v7, v37
  v_xor_b32 v39, v7, v39
  v_xor_b32 v37, 2, v37
  v_xor_b32 v39, 2, v39
  v_or_b32 v37, v37, v39
  v_cmp_ne_u32 vcc, 0, v37
  s_cbranch_vccnz SC_117
SD_119:
  v_add_f32 v36, v36, v36 row_ror:8
  v_add_f32 v38, v38, v38 row_ror:8
  s_nop 1
  v_permlane16_swap_b32 v36, v38
  v_add_f32 v36, v36, v38
  v_mov_b32 v39, v36
  s_nop 1
  v_permlane32_swap_b32 v36, v39
  v_add_f32 v36, v36, v39
  v_mov_b32 v38, v36
  s_nop 1
  v_permlane16_swap_b32 v36, v38
  v_mul_f32 v36, s61, v36
  v_mul_f32 v38, s61, v38
  v_fma_f32 v38, -v36, v36, v38
  v_max_f32 v38, 0, v38
  v_add_f32 v38, s62, v38
  v_rsq_f32 v8, v38
  s_add_u32 s14, s19, 49152
  s_add_u32 s67, s26, 0
  s_mov_b32 m0, s57
  s_add_u32 s66, s67, s68
  s_add_u32 s56, s67, 22528
  buffer_load_dword v12, v15, s[40:43], s14 offen sc1
  s_waitcnt vmcnt(0)
SK_121:
  v_cmp_ne_u32 vcc, s9, v12
  s_cbranch_vccnz SC_120
SD_122:
  buffer_load_dwordx4 v9, s[40:43], s66 offen sc1 lds
  s_add_u32 m0, m0, 1024
  s_add_u32 s66, s66, 1024
  s_cmp_eq_u32 s66, s56
  s_cselect_b32 s66, s67, s66
  buffer_load_dwordx4 v9, s[40:43], s66 offen sc1 lds
  s_add_u32 m0, m0, 1024
  s_add_u32 s66, s66, 1024
  s_cmp_eq_u32 s66, s56
  s_cselect_b32 s66, s67, s66
  buffer_load_dwordx4 v9, s[40:43], s66 offen sc1 lds
  s_add_u32 m0, m0, 1024
  s_add_u32 s66, s66, 1024
  s_cmp_eq_u32 s66, s56
  s_cselect_b32 s66, s67, s66
  buffer_load_dwordx4 v9, s[40:43], s66 offen sc1 lds
  s_add_u32 m0, m0, 1024
  s_add_u32 s66, s66, 1024
  s_cmp_eq_u32 s66, s56
  s_cselect_b32 s66, s67, s66
  buffer_load_dwordx4 v9, s[40:43], s66 offen sc1 lds
  s_add_u32 m0, m0, 1024
  s_add_u32 s66, s66, 1024
  s_cmp_eq_u32 s66, s56
  s_cselect_b32 s66, s67, s66
  buffer_load_dwordx4 v9, s[40:43], s66 offen sc1 lds
  s_add_u32 m0, m0, 1024
  s_add_u32 s66, s66, 1024
  s_cmp_eq_u32 s66, s56
  s_cselect_b32 s66, s67, s66
  buffer_load_dwordx4 v9, s[40:43], s66 offen sc1 lds
  s_add_u32 m0, m0, 1024
  s_add_u32 s66, s66, 1024
  s_cmp_eq_u32 s66, s56
  s_cselect_b32 s66, s67, s66
  buffer_load_dwordx4 v9, s[40:43], s66 offen sc1 lds
  s_add_u32 m0, m0, 1024
  s_add_u32 s66, s66, 1024
  s_cmp_eq_u32 s66, s56
  s_cselect_b32 s66, s67, s66
  buffer_load_dwordx4 v9, s[40:43], s66 offen sc1 lds
  s_add_u32 m0, m0, 1024
  s_add_u32 s66, s66, 1024
  s_cmp_eq_u32 s66, s56
  s_cselect_b32 s66, s67, s66
  buffer_load_dwordx4 v9, s[40:43], s66 offen sc1 lds
  s_add_u32 m0, m0, 1024
  s_add_u32 s66, s66, 1024
  s_cmp_eq_u32 s66, s56
  s_cselect_b32 s66, s67, s66
  buffer_load_dwordx4 v9, s[40:43], s66 offen sc1 lds
  s_add_u32 m0, m0, 1024
  s_add_u32 s66, s66, 1024
  s_cmp_eq_u32 s66, s56
  s_cselect_b32 s66, s67, s66
  buffer_load_dwordx4 v9, s[40:43], s66 offen sc1 lds
  s_add_u32 m0, m0, 1024
  s_add_u32 s66, s66, 1024
  s_cmp_eq_u32 s66, s56
  s_cselect_b32 s66, s67, s66
  buffer_load_dwordx4 v9, s[40:43], s66 offen sc1 lds
  s_add_u32 m0, m0, 1024
  s_add_u32 s66, s66, 1024
  s_cmp_eq_u32 s66, s56
  s_cselect_b32 s66, s67, s66
  buffer_load_dwordx4 v9, s[40:43], s66 offen sc1 lds
  s_add_u32 m0, m0, 1024
  s_add_u32 s66, s66, 1024
  s_cmp_eq_u32 s66, s56
  s_cselect_b32 s66, s67, s66
  buffer_load_dwordx4 v9, s[40:43], s66 offen sc1 lds
  s_add_u32 m0, m0, 1024
  s_add_u32 s66, s66, 1024
  s_cmp_eq_u32 s66, s56
  s_cselect_b32 s66, s67, s66
  buffer_load_dwordx4 v9, s[40:43], s66 offen sc1 lds
  s_add_u32 m0, m0, 1024
  s_add_u32 s66, s66, 1024
  s_cmp_eq_u32 s66, s56
  s_cselect_b32 s66, s67, s66
  s_setprio 1
  s_waitcnt vmcnt(15)
  ds_read_b128 v[28:31], v19 offset:0
  buffer_load_dwordx4 v9, s[40:43], s66 offen sc1 lds
  s_add_u32 m0, m0, 1024
  s_add_u32 s66, s66, 1024
  s_cmp_eq_u32 s66, s56
  s_cselect_b32 s66, s67, s66
  s_waitcnt vmcnt(15)
  ds_read_b128 v[32:35], v19 offset:1024
  buffer_load_dwordx4 v9, s[40:43], s66 offen sc1 lds
  s_add_u32 m0, m0, 1024
  s_add_u32 s66, s66, 1024
  s_cmp_eq_u32 s66, s56
  s_cselect_b32 s66, s67, s66
  s_waitcnt lgkmcnt(1)
  v_mfma_f32_32x32x16_bf16 v[48:63], v[80:83], v[28:31], 0
  buffer_load_dwordx4 v9, s[40:43], s66 offen sc1 lds
  s_add_u32 m0, m0, 1024
  s_add_u32 s66, s66, 1024
  s_cmp_eq_u32 s66, s56
  s_cselect_b32 s66, s67, s66
  v_mfma_f32_32x32x16_bf16 v[64:79], v[84:87], v[28:31], 0
  s_waitcnt vmcnt(16)
  ds_read_b128 v[36:39], v19 offset:2048
  s_waitcnt lgkmcnt(1)
  v_mfma_f32_32x32x16_bf16 v[48:63], v[88:91], v[32:35], v[48:63]
  buffer_load_dwordx4 v9, s[40:43], s66 offen sc1 lds
  s_add_u32 m0, m0, 1024
  s_add_u32 s66, s66, 1024
  s_cmp_eq_u32 s66, s56
  s_cselect_b32 s66, s67, s66
  v_mfma_f32_32x32x16_bf16 v[64:79], v[92:95], v[32:35], v[64:79]
  s_waitcnt vmcnt(16)
  ds_read_b128 v[40:43], v19 offset:3072
  s_waitcnt lgkmcnt(1)
  v_mfma_f32_32x32x16_bf16 v[48:63], v[96:99], v[36:39], v[48:63]
  buffer_load_dwordx4 v9, s[40:43], s66 offen sc1 lds
  s_add_u32 m0, m0, 1024
  s_add_u32 s66, s66, 1024
  s_cmp_eq_u32 s66, s56
  s_cselect_b32 s66, s67, s66
  v_mfma_f32_32x32x16_bf16 v[64:79], v[100:103], v[36:39], v[64:79]
  s_waitcnt vmcnt(16)
  ds_read_b128 v[44:47], v19 offset:4096
  s_waitcnt lgkmcnt(1)
  v_mfma_f32_32x32x16_bf16 v[48:63], v[104:107], v[40:43], v[48:63]
  buffer_load_dwordx4 v9, s[40:43], s66 offen sc1 lds
  v_mfma_f32_32x32x16_bf16 v[64:79], v[108:111], v[40:43], v[64:79]
  s_waitcnt vmcnt(16)
  ds_read_b128 v[28:31], v19 offset:5120
  s_waitcnt lgkmcnt(1)
  v_mfma_f32_32x32x16_bf16 v[48:63], v[112:115], v[44:47], v[48:63]
  v_mfma_f32_32x32x16_bf16 v[64:79], v[116:119], v[44:47], v[64:79]
  s_waitcnt vmcnt(15)
  ds_read_b128 v[32:35], v19 offset:6144
  s_waitcnt lgkmcnt(1)
  v_mfma_f32_32x32x16_bf16 v[48:63], v[120:123], v[28:31], v[48:63]
  v_mfma_f32_32x32x16_bf16 v[64:79], v[124:127], v[28:31], v[64:79]
  s_waitcnt vmcnt(14)
  ds_read_b128 v[36:39], v19 offset:7168
  s_waitcnt lgkmcnt(1)
  v_mfma_f32_32x32x16_bf16 v[48:63], v[128:131], v[32:35], v[48:63]
  v_mfma_f32_32x32x16_bf16 v[64:79], v[132:135], v[32:35], v[64:79]
  s_waitcnt vmcnt(13)
  ds_read_b128 v[40:43], v19 offset:8192
  s_waitcnt lgkmcnt(1)
  v_mfma_f32_32x32x16_bf16 v[48:63], v[136:139], v[36:39], v[48:63]
  v_mfma_f32_32x32x16_bf16 v[64:79], v[140:143], v[36:39], v[64:79]
  s_waitcnt vmcnt(12)
  ds_read_b128 v[44:47], v19 offset:9216
  s_waitcnt lgkmcnt(1)
  v_mfma_f32_32x32x16_bf16 v[48:63], v[144:147], v[40:43], v[48:63]
  v_mfma_f32_32x32x16_bf16 v[64:79], v[148:151], v[40:43], v[64:79]
  s_waitcnt vmcnt(11)
  ds_read_b128 v[28:31], v19 offset:10240
  s_waitcnt lgkmcnt(1)
  v_mfma_f32_32x32x16_bf16 v[48:63], v[152:155], v[44:47], v[48:63]
  v_mfma_f32_32x32x16_bf16 v[64:79], v[156:159], v[44:47], v[64:79]
  s_waitcnt vmcnt(10)
  ds_read_b128 v[32:35], v19 offset:11264
  s_waitcnt lgkmcnt(1)
  v_mfma_f32_32x32x16_bf16 v[48:63], v[160:163], v[28:31], v[48:63]
  v_mfma_f32_32x32x16_bf16 v[64:79], v[164:167], v[28:31], v[64:79]
  s_waitcnt vmcnt(9)
  ds_read_b128 v[36:39], v19 offset:12288
  s_waitcnt lgkmcnt(1)
  v_mfma_f32_32x32x16_bf16 v[48:63], v[168:171], v[32:35], v[48:63]
  v_mfma_f32_32x32x16_bf16 v[64:79], v[172:175], v[32:35], v[64:79]
  s_waitcnt vmcnt(8)
  ds_read_b128 v[40:43], v19 offset:13312
  ds_read_b32 v3, v5 offset:56
  s_waitcnt lgkmcnt(2)
  v_mfma_f32_32x32x16_bf16 v[48:63], v[176:179], v[36:39], v[48:63]
  v_mfma_f32_32x32x16_bf16 v[64:79], v[180:183], v[36:39], v[64:79]
  s_waitcnt vmcnt(7)
  ds_read_b128 v[44:47], v19 offset:14336
  s_waitcnt vmcnt(6)
  ds_read_b128 v[28:31], v19 offset:15360
  s_waitcnt lgkmcnt(3)
  v_mfma_f32_32x32x16_bf16 v[48:63], v[184:187], v[40:43], v[48:63]
  v_mfma_f32_32x32x16_bf16 v[64:79], v[188:191], v[40:43], v[64:79]
  s_waitcnt vmcnt(5)
  ds_read_b128 v[32:35], v19 offset:16384
  s_waitcnt lgkmcnt(2)
  v_mfma_f32_32x32x16_bf16 v[48:63], v[192:195], v[44:47], v[48:63]
  s_waitcnt vmcnt(4)
  ds_read_b128 v[36:39], v19 offset:17408
  s_waitcnt lgkmcnt(2)
  v_mfma_f32_32x32x16_bf16 v[48:63], v[200:203], v[28:31], v[48:63]
  s_waitcnt vmcnt(3)
  ds_read_b128 v[40:43], v19 offset:18432
  s_waitcnt lgkmcnt(2)
  v_mfma_f32_32x32x16_bf16 v[48:63], v[208:211], v[32:35], v[48:63]
  s_waitcnt vmcnt(2)
  ds_read_b128 v[44:47], v19 offset:19456
  s_waitcnt lgkmcnt(2)
  v_mfma_f32_32x32x16_bf16 v[48:63], v[216:219], v[36:39], v[48:63]
  s_waitcnt vmcnt(1)
  ds_read_b128 v[28:31], v19 offset:20480
  s_waitcnt lgkmcnt(2)
  v_mfma_f32_32x32x16_bf16 v[48:63], v[224:227], v[40:43], v[48:63]
  s_waitcnt vmcnt(0)
  ds_read_b128 v[32:35], v19 offset:21504
  s_waitcnt lgkmcnt(2)
  v_mfma_f32_32x32x16_bf16 v[48:63], v[232:235], v[44:47], v[48:63]
  ds_read_b128 v[36:39], v19 offset:14336
  s_waitcnt lgkmcnt(2)
  v_mfma_f32_32x32x16_bf16 v[48:63], v[240:243], v[28:31], v[48:63]
  s_add_u32 s14, s19, 65536
  buffer_load_dword v12, v15, s[40:43], s14 offen sc1
  ds_read_b128 v[40:43], v19 offset:15360
  s_waitcnt lgkmcnt(2)
  v_mfma_f32_32x32x16_bf16 v[48:63], v[248:251], v[32:35], v[48:63]
  ds_read_b128 v[44:47], v19 offset:16384
  s_waitcnt lgkmcnt(2)
  v_mfma_f32_32x32x16_bf16 v[64:79], v[196:199], v[36:39], v[64:79]
  ds_read_b128 v[28:31], v19 offset:17408
SK_124:
  v_cmp_gt_u32 vcc, 4, v3
  s_cbranch_vccnz SC_123
SD_125:
  s_waitcnt lgkmcnt(2)
  v_mfma_f32_32x32x16_bf16 v[64:79], v[204:207], v[40:43], v[64:79]
  ds_read_b128 v[32:35], v19 offset:18432
  v_xor_b32 v1, 0, v13
  s_nop 1
  ds_write_b128 v1, v[48:51] offset:0
  s_waitcnt lgkmcnt(3)
  v_mfma_f32_32x32x16_bf16 v[64:79], v[212:215], v[44:47], v[64:79]
  ds_read_b128 v[36:39], v19 offset:19456
  v_xor_b32 v2, 16, v13
  ds_write_b128 v2, v[52:55] offset:0
  s_waitcnt lgkmcnt(4)
  v_mfma_f32_32x32x16_bf16 v[64:79], v[220:223], v[28:31], v[64:79]
  ds_read_b128 v[40:43], v19 offset:20480
  v_xor_b32 v1, 160, v13
  ds_write_b128 v1, v[56:59] offset:0
  s_waitcnt lgkmcnt(5)
  v_mfma_f32_32x32x16_bf16 v[64:79], v[228:231], v[32:35], v[64:79]
  ds_read_b128 v[44:47], v19 offset:21504
  v_xor_b32 v2, 176, v13
  ds_write_b128 v2, v[60:63] offset:0
  s_waitcnt lgkmcnt(5)
  v_mfma_f32_32x32x16_bf16 v[64:79], v[236:239], v[36:39], v[64:79]
  s_waitcnt lgkmcnt(3)
  v_mfma_f32_32x32x16_bf16 v[64:79], v[244:247], v[40:43], v[64:79]
  s_waitcnt vmcnt(0)
  v_cmp_ne_u32 vcc, s9, v12
  s_add_u32 s67, s26, 2883584
  s_mov_b32 m0, s57
  s_cmp_eq_u64 vcc, 0
  s_cselect_b32 s59, 1, 0
  s_cselect_b32 s67, s67, 2130706432
  s_add_u32 s66, s67, s68
  s_add_u32 s56, s67, 22528
  buffer_load_dwordx4 v9, s[40:43], s66 offen sc1 lds
  s_add_u32 m0, m0, 1024
  s_add_u32 s66, s66, 1024
  s_cmp_eq_u32 s66, s56
  s_cselect_b32 s66, s67, s66
  s_waitcnt lgkmcnt(1)
  v_mfma_f32_32x32x16_bf16 v[64:79], v[252:255], v[44:47], v[64:79]
  buffer_load_dwordx4 v9, s[40:43], s66 offen sc1 lds
  s_add_u32 m0, m0, 1024
  s_add_u32 s66, s66, 1024
  s_cmp_eq_u32 s66, s56
  s_cselect_b32 s66, s67, s66
  v_xor_b32 v1, 64, v13
  s_nop 5
  ds_write_b128 v1, v[64:67] offset:0
  buffer_load_dwordx4 v9, s[40:43], s66 offen sc1 lds
  s_add_u32 m0, m0, 1024
  s_add_u32 s66, s66, 1024
  s_cmp_eq_u32 s66, s56
  s_cselect_b32 s66, s67, s66
  v_xor_b32 v2, 80, v13
  ds_write_b128 v2, v[68:71] offset:0
  buffer_load_dwordx4 v9, s[40:43], s66 offen sc1 lds
  s_add_u32 m0, m0, 1024
  s_add_u32 s66, s66, 1024
  s_cmp_eq_u32 s66, s56
  s_cselect_b32 s66, s67, s66
  v_xor_b32 v1, 224, v13
  ds_write_b128 v1, v[72:75] offset:0
  buffer_load_dwordx4 v9, s[40:43], s66 offen sc1 lds
  s_add_u32 m0, m0, 1024
  s_add_u32 s66, s66, 1024
  s_cmp_eq_u32 s66, s56
  s_cselect_b32 s66, s67, s66
  v_xor_b32 v2, 240, v13
  ds_write_b128 v2, v[76:79] offset:0
  buffer_load_dwordx4 v9, s[40:43], s66 offen sc1 lds
  s_add_u32 m0, m0, 1024
  s_add_u32 s66, s66, 1024
  s_cmp_eq_u32 s66, s56
  s_cselect_b32 s66, s67, s66
  s_mov_b64 exec, 1
  ds_add_u32 v5, v6 offset:72
  s_mov_b64 exec, -1
  s_setprio 0
  buffer_load_dword v12, v15, s[40:43], s14 offen sc1
  s_cmp_eq_u32 s59, 1
  s_cbranch_scc1 HPRE_126
  s_add_u32 s67, s26, 2883584
  s_mov_b32 m0, s57
  s_add_u32 s66, s67, s68
  s_add_u32 s56, s67, 22528
  s_waitcnt vmcnt(0)
SK_128:
  v_cmp_ne_u32 vcc, s9, v12
  s_cbranch_vccnz SC_127
SD_129:
  buffer_load_dwordx4 v9, s[40:43], s66 offen sc1 lds
  s_add_u32 m0, m0, 1024
  s_add_u32 s66, s66, 1024
  s_cmp_eq_u32 s66, s56
  s_cselect_b32 s66, s67, s66
  buffer_load_dwordx4 v9, s[40:43], s66 offen sc1 lds
  s_add_u32 m0, m0, 1024
  s_add_u32 s66, s66, 1024
  s_cmp_eq_u32 s66, s56
  s_cselect_b32 s66, s67, s66
  buffer_load_dwordx4 v9, s[40:43], s66 offen sc1 lds
  s_add_u32 m0, m0, 1024
  s_add_u32 s66, s66, 1024
  s_cmp_eq_u32 s66, s56
  s_cselect_b32 s66, s67, s66
  buffer_load_dwordx4 v9, s[40:43], s66 offen sc1 lds
  s_add_u32 m0, m0, 1024
  s_add_u32 s66, s66, 1024
  s_cmp_eq_u32 s66, s56
  s_cselect_b32 s66, s67, s66
  buffer_load_dwordx4 v9, s[40:43], s66 offen sc1 lds
  s_add_u32 m0, m0, 1024
  s_add_u32 s66, s66, 1024
  s_cmp_eq_u32 s66, s56
  s_cselect_b32 s66, s67, s66
  buffer_load_dwordx4 v9, s[40:43], s66 offen sc1 lds
  s_add_u32 m0, m0, 1024
  s_add_u32 s66, s66, 1024
  s_cmp_eq_u32 s66, s56
  s_cselect_b32 s66, s67, s66
HPRE_126:
  s_setprio 1
  s_waitcnt vmcnt(5)
  ds_read_b128 v[28:31], v19 offset:0
  buffer_load_dwordx4 v9, s[40:43], s66 offen sc1 lds
  s_add_u32 m0, m0, 1024
  s_add_u32 s66, s66, 1024
  s_cmp_eq_u32 s66, s56
  s_cselect_b32 s66, s67, s66
  s_waitcnt vmcnt(5)
  ds_read_b128 v[32:35], v19 offset:1024
  buffer_load_dwordx4 v9, s[40:43], s66 offen sc1 lds
  s_add_u32 m0, m0, 1024
  s_add_u32 s66, s66, 1024
  s_cmp_eq_u32 s66, s56
  s_cselect_b32 s66, s67, s66
  s_waitcnt lgkmcnt(1)
  v_mfma_f32_32x32x16_bf16 v[48:63], v[80:83], v[28:31], 0
  buffer_load_dwordx4 v9, s[40:43], s66 offen sc1 lds
  s_add_u32 m0, m0, 1024
  s_add_u32 s66, s66, 1024
  s_cmp_eq_u32 s66, s56
  s_cselect_b32 s66, s67, s66
  buffer_load_dwordx4 v9, s[40:43], s66 offen sc1 lds
  s_add_u32 m0, m0, 1024
  s_add_u32 s66, s66, 1024
  s_cmp_eq_u32 s66, s56
  s_cselect_b32 s66, s67, s66
  v_mfma_f32_32x32x16_bf16 v[64:79], v[84:87], v[28:31], 0
  s_waitcnt vmcnt(7)
  ds_read_b128 v[36:39], v19 offset:2048
  s_waitcnt lgkmcnt(1)
  v_mfma_f32_32x32x16_bf16 v[48:63], v[88:91], v[32:35], v[48:63]
  buffer_load_dwordx4 v9, s[40:43], s66 offen sc1 lds
  s_add_u32 m0, m0, 1024
  s_add_u32 s66, s66, 1024
  s_cmp_eq_u32 s66, s56
  s_cselect_b32 s66, s67, s66
  v_mfma_f32_32x32x16_bf16 v[64:79], v[92:95], v[32:35], v[64:79]
  s_waitcnt vmcnt(7)
  ds_read_b128 v[40:43], v19 offset:3072
  s_waitcnt lgkmcnt(1)
  v_mfma_f32_32x32x16_bf16 v[48:63], v[96:99], v[36:39], v[48:63]
  buffer_load_dwordx4 v9, s[40:43], s66 offen sc1 lds
  s_add_u32 m0, m0, 1024
  s_add_u32 s66, s66, 1024
  s_cmp_eq_u32 s66, s56
  s_cselect_b32 s66, s67, s66
  v_mfma_f32_32x32x16_bf16 v[64:79], v[100:103], v[36:39], v[64:79]
  s_waitcnt vmcnt(7)
  ds_read_b128 v[44:47], v19 offset:4096
  s_waitcnt lgkmcnt(1)
  v_mfma_f32_32x32x16_bf16 v[48:63], v[104:107], v[40:43], v[48:63]
  buffer_load_dwordx4 v9, s[40:43], s66 offen sc1 lds
  s_add_u32 m0, m0, 1024
  s_add_u32 s66, s66, 1024
  s_cmp_eq_u32 s66, s56
  s_cselect_b32 s66, s67, s66
  v_mfma_f32_32x32x16_bf16 v[64:79], v[108:111], v[40:43], v[64:79]
  s_waitcnt vmcnt(7)
  ds_read_b128 v[28:31], v19 offset:5120
  s_waitcnt lgkmcnt(1)
  v_mfma_f32_32x32x16_bf16 v[48:63], v[112:115], v[44:47], v[48:63]
  buffer_load_dwordx4 v9, s[40:43], s66 offen sc1 lds
  s_add_u32 m0, m0, 1024
  s_add_u32 s66, s66, 1024
  s_cmp_eq_u32 s66, s56
  s_cselect_b32 s66, s67, s66
  v_mfma_f32_32x32x16_bf16 v[64:79], v[116:119], v[44:47], v[64:79]
  s_waitcnt vmcnt(7)
  ds_read_b128 v[32:35], v19 offset:6144
  s_waitcnt lgkmcnt(1)
  v_mfma_f32_32x32x16_bf16 v[48:63], v[120:123], v[28:31], v[48:63]
  buffer_load_dwordx4 v9, s[40:43], s66 offen sc1 lds
  s_add_u32 m0, m0, 1024
  s_add_u32 s66, s66, 1024
  s_cmp_eq_u32 s66, s56
  s_cselect_b32 s66, s67, s66
  v_mfma_f32_32x32x16_bf16 v[64:79], v[124:127], v[28:31], v[64:79]
  s_waitcnt vmcnt(7)
  ds_read_b128 v[36:39], v19 offset:7168
  s_waitcnt lgkmcnt(1)
  v_mfma_f32_32x32x16_bf16 v[48:63], v[128:131], v[32:35], v[48:63]
  buffer_load_dwordx4 v9, s[40:43], s66 offen sc1 lds
  s_add_u32 m0, m0, 1024
  s_add_u32 s66, s66, 1024
  s_cmp_eq_u32 s66, s56
  s_cselect_b32 s66, s67, s66
  v_mfma_f32_32x32x16_bf16 v[64:79], v[132:135], v[32:35], v[64:79]
  s_waitcnt vmcnt(7)
  ds_read_b128 v[40:43], v19 offset:8192
  s_waitcnt lgkmcnt(1)
  v_mfma_f32_32x32x16_bf16 v[48:63], v[136:139], v[36:39], v[48:63]
  buffer_load_dwordx4 v9, s[40:43], s66 offen sc1 lds
  s_add_u32 m0, m0, 1024
  s_add_u32 s66, s66, 1024
  s_cmp_eq_u32 s66, s56
  s_cselect_b32 s66, s67, s66
  v_mfma_f32_32x32x16_bf16 v[64:79], v[140:143], v[36:39], v[64:79]
  s_waitcnt vmcnt(7)
  ds_read_b128 v[44:47], v19 offset:9216
  s_waitcnt lgkmcnt(1)
  v_mfma_f32_32x32x16_bf16 v[48:63], v[144:147], v[40:43], v[48:63]
  buffer_load_dwordx4 v9, s[40:43], s66 offen sc1 lds
  s_add_u32 m0, m0, 1024
  s_add_u32 s66, s66, 1024
  s_cmp_eq_u32 s66, s56
  s_cselect_b32 s66, s67, s66
  v_mfma_f32_32x32x16_bf16 v[64:79], v[148:151], v[40:43], v[64:79]
  s_waitcnt vmcnt(7)
  ds_read_b128 v[28:31], v19 offset:10240
  s_waitcnt lgkmcnt(1)
  v_mfma_f32_32x32x16_bf16 v[48:63], v[152:155], v[44:47], v[48:63]
  buffer_load_dwordx4 v9, s[40:43], s66 offen sc1 lds
  s_add_u32 m0, m0, 1024
  s_add_u32 s66, s66, 1024
  s_cmp_eq_u32 s66, s56
  s_cselect_b32 s66, s67, s66
  v_mfma_f32_32x32x16_bf16 v[64:79], v[156:159], v[44:47], v[64:79]
  s_waitcnt vmcnt(7)
  ds_read_b128 v[32:35], v19 offset:11264
  s_waitcnt lgkmcnt(1)
  v_mfma_f32_32x32x16_bf16 v[48:63], v[160:163], v[28:31], v[48:63]
  buffer_load_dwordx4 v9, s[40:43], s66 offen sc1 lds
  s_add_u32 m0, m0, 1024
  s_add_u32 s66, s66, 1024
  s_cmp_eq_u32 s66, s56
  s_cselect_b32 s66, s67, s66
  v_mfma_f32_32x32x16_bf16 v[64:79], v[164:167], v[28:31], v[64:79]
  s_waitcnt vmcnt(7)
  ds_read_b128 v[36:39], v19 offset:12288
  s_waitcnt lgkmcnt(1)
  v_mfma_f32_32x32x16_bf16 v[48:63], v[168:171], v[32:35], v[48:63]
  buffer_load_dwordx4 v9, s[40:43], s66 offen sc1 lds
  s_add_u32 m0, m0, 1024
  s_add_u32 s66, s66, 1024
  s_cmp_eq_u32 s66, s56
  s_cselect_b32 s66, s67, s66
  v_mfma_f32_32x32x16_bf16 v[64:79], v[172:175], v[32:35], v[64:79]
  s_waitcnt vmcnt(7)
  ds_read_b128 v[40:43], v19 offset:13312
  ds_read_b32 v3, v5 offset:60
  s_waitcnt lgkmcnt(2)
  v_mfma_f32_32x32x16_bf16 v[48:63], v[176:179], v[36:39], v[48:63]
  buffer_load_dwordx4 v9, s[40:43], s66 offen sc1 lds
  s_mov_b64 exec, 1
  ds_add_u32 v5, v6 offset:28
  s_mov_b64 exec, -1
  v_mfma_f32_32x32x16_bf16 v[64:79], v[180:183], v[36:39], v[64:79]
  s_waitcnt vmcnt(7)
  ds_read_b128 v[44:47], v19 offset:14336
  s_waitcnt vmcnt(6)
  ds_read_b128 v[28:31], v19 offset:15360
  s_waitcnt lgkmcnt(4)
  v_mfma_f32_32x32x16_bf16 v[48:63], v[184:187], v[40:43], v[48:63]
  v_mfma_f32_32x32x16_bf16 v[64:79], v[188:191], v[40:43], v[64:79]
  s_waitcnt vmcnt(5)
  ds_read_b128 v[32:35], v19 offset:16384
  s_waitcnt lgkmcnt(2)
  v_mfma_f32_32x32x16_bf16 v[48:63], v[192:195], v[44:47], v[48:63]
  s_waitcnt vmcnt(4)
  ds_read_b128 v[36:39], v19 offset:17408
  s_waitcnt lgkmcnt(2)
  v_mfma_f32_32x32x16_bf16 v[48:63], v[200:203], v[28:31], v[48:63]
  s_waitcnt vmcnt(3)
  ds_read_b128 v[40:43], v19 offset:18432
  s_waitcnt lgkmcnt(2)
  v_mfma_f32_32x32x16_bf16 v[48:63], v[208:211], v[32:35], v[48:63]
  s_waitcnt vmcnt(2)
  ds_read_b128 v[44:47], v19 offset:19456
  s_waitcnt lgkmcnt(2)
  v_mfma_f32_32x32x16_bf16 v[48:63], v[216:219], v[36:39], v[48:63]
  s_waitcnt vmcnt(1)
  ds_read_b128 v[28:31], v19 offset:20480
  s_waitcnt lgkmcnt(2)
  v_mfma_f32_32x32x16_bf16 v[48:63], v[224:227], v[40:43], v[48:63]
  s_waitcnt vmcnt(0)
  ds_read_b128 v[32:35], v19 offset:21504
  s_waitcnt lgkmcnt(2)
  v_mfma_f32_32x32x16_bf16 v[48:63], v[232:235], v[44:47], v[48:63]
  ds_read_b128 v[36:39], v19 offset:14336
  s_waitcnt lgkmcnt(2)
  v_mfma_f32_32x32x16_bf16 v[48:63], v[240:243], v[28:31], v[48:63]
  ds_read_b128 v[40:43], v19 offset:15360
  s_waitcnt lgkmcnt(2)
  v_mfma_f32_32x32x16_bf16 v[48:63], v[248:251], v[32:35], v[48:63]
  ds_read_b128 v[44:47], v19 offset:16384
  s_waitcnt lgkmcnt(2)
  v_mfma_f32_32x32x16_bf16 v[64:79], v[196:199], v[36:39], v[64:79]
  ds_read_b128 v[28:31], v19 offset:17408
SK_131:
  v_cmp_gt_u32 vcc, 4, v3
  s_cbranch_vccnz SC_130
SD_132:
  s_waitcnt lgkmcnt(2)
  v_mfma_f32_32x32x16_bf16 v[64:79], v[204:207], v[40:43], v[64:79]
  ds_read_b128 v[32:35], v19 offset:18432
  v_xor_b32 v1, 0, v13
  s_nop 1
  ds_write_b128 v1, v[48:51] offset:32768
  s_waitcnt lgkmcnt(3)
  v_mfma_f32_32x32x16_bf16 v[64:79], v[212:215], v[44:47], v[64:79]
  ds_read_b128 v[36:39], v19 offset:19456
  v_xor_b32 v2, 16, v13
  ds_write_b128 v2, v[52:55] offset:32768
  s_waitcnt lgkmcnt(4)
  v_mfma_f32_32x32x16_bf16 v[64:79], v[220:223], v[28:31], v[64:79]
  ds_read_b128 v[40:43], v19 offset:20480
  v_xor_b32 v1, 160, v13
  ds_write_b128 v1, v[56:59] offset:32768
  s_waitcnt lgkmcnt(5)
  v_mfma_f32_32x32x16_bf16 v[64:79], v[228:231], v[32:35], v[64:79]
  ds_read_b128 v[44:47], v19 offset:21504
  v_xor_b32 v2, 176, v13
  ds_write_b128 v2, v[60:63] offset:32768
  s_waitcnt lgkmcnt(5)
  v_mfma_f32_32x32x16_bf16 v[64:79], v[236:239], v[36:39], v[64:79]
  s_waitcnt lgkmcnt(3)
  v_mfma_f32_32x32x16_bf16 v[64:79], v[244:247], v[40:43], v[64:79]
  s_waitcnt lgkmcnt(1)
  v_mfma_f32_32x32x16_bf16 v[64:79], v[252:255], v[44:47], v[64:79]
  v_xor_b32 v1, 64, v13
  s_nop 10
  ds_write_b128 v1, v[64:67] offset:32768
  v_xor_b32 v2, 80, v13
  ds_write_b128 v2, v[68:71] offset:32768
  v_xor_b32 v1, 224, v13
  ds_write_b128 v1, v[72:75] offset:32768
  v_xor_b32 v2, 240, v13
  ds_write_b128 v2, v[76:79] offset:32768
  s_mov_b64 exec, 1
  ds_add_u32 v5, v6 offset:76
  s_mov_b64 exec, -1
  v_xor_b32 v37, 128, v14
  ds_read_b32 v36, v5 offset:76
  s_waitcnt lgkmcnt(0)
SK_134:
  v_cmp_gt_u32 vcc, 4, v36
  s_cbranch_vccnz SC_133
SD_135:
  ds_read_b128 v[48:51], v14 offset:0
  ds_read_b128 v[52:55], v37 offset:0
  ds_read_b128 v[56:59], v14 offset:8192
  ds_read_b128 v[60:63], v37 offset:8192
  ds_read_b128 v[64:67], v14 offset:16384
  ds_read_b128 v[68:71], v37 offset:16384
  ds_read_b128 v[72:75], v14 offset:24576
  ds_read_b128 v[76:79], v37 offset:24576
  s_waitcnt lgkmcnt(4)
  v_add_f32 v48, v48, v56
  v_add_f32 v49, v49, v57
  v_add_f32 v50, v50, v58
  v_add_f32 v51, v51, v59
  v_add_f32 v52, v52, v60
  v_add_f32 v53, v53, v61
  v_add_f32 v54, v54, v62
  v_add_f32 v55, v55, v63
  v_lshlrev_b32 v56, 16, v20
  v_and_b32 v57, 0xffff0000, v20
  v_lshlrev_b32 v58, 16, v21
  v_and_b32 v59, 0xffff0000, v21
  v_lshlrev_b32 v60, 16, v22
  v_and_b32 v61, 0xffff0000, v22
  v_lshlrev_b32 v62, 16, v23
  v_and_b32 v63, 0xffff0000, v23
  v_fma_f32 v56, v48, v8, v56
  v_fma_f32 v57, v49, v8, v57
  v_fma_f32 v58, v50, v8, v58
  v_fma_f32 v59, v51, v8, v59
  v_fma_f32 v60, v52, v8, v60
  v_fma_f32 v61, v53, v8, v61
  v_fma_f32 v62, v54, v8, v62
  v_fma_f32 v63, v55, v8, v63
  s_waitcnt lgkmcnt(0)
  v_add_f32 v64, v64, v72
  v_add_f32 v65, v65, v73
  v_add_f32 v66, v66, v74
  v_add_f32 v67, v67, v75
  v_add_f32 v68, v68, v76
  v_add_f32 v69, v69, v77
  v_add_f32 v70, v70, v78
  v_add_f32 v71, v71, v79
  v_fma_f32 v56, v64, v8, v56
  v_fma_f32 v57, v65, v8, v57
  v_fma_f32 v58, v66, v8, v58
  v_fma_f32 v59, v67, v8, v59
  v_fma_f32 v60, v68, v8, v60
  v_fma_f32 v61, v69, v8, v61
  v_fma_f32 v62, v70, v8, v62
  v_fma_f32 v63, v71, v8, v63
  v_cvt_pk_bf16_f32 v20, v56, v57
  v_cvt_pk_bf16_f32 v21, v58, v59
  v_cvt_pk_bf16_f32 v22, v60, v61
  v_cvt_pk_bf16_f32 v23, v62, v63
  s_add_u32 s11, s25, 1048576
  buffer_store_dwordx4 v[20:23], v18, s[52:55], s11 offen
  s_or_b32 s11, s2, s15
  s_cmp_lg_u32 s11, 0
  s_cbranch_scc1 EP_136
  s_mov_b64 exec, 1
  buffer_store_dword v7, off, s[40:43], 0 sc1
  s_mov_b64 exec, -1
EP_136:
L_FIN0:
  s_endpgm
SC_3:
  s_add_u32 s10, s10, 1
  s_cmp_gt_u32 s10, 0x20000
  s_cbranch_scc1 SD_5
  ds_read_b32 v40, v5 offset:92
  s_waitcnt lgkmcnt(0)
  s_branch SK_4
SC_6:
  s_add_u32 s10, s10, 1
  s_cmp_gt_u32 s10, 0x20000
  s_cbranch_scc1 SD_8
  ds_read_b32 v40, v5 offset:96
  s_waitcnt lgkmcnt(0)
  s_branch SK_7
MC_9:
  s_mov_b32 s28, 0
  s_sub_u32 s11, s11, 1
  s_cbranch_scc1 MD_11
  global_load_dword v103, v102, s[36:37] sc1
  s_waitcnt vmcnt(0)
  s_branch MK_10
UW_12:
  buffer_wbl2 sc1
  s_waitcnt vmcnt(0)
  s_branch UD_13
LC_14:
  buffer_store_dword v7, off, s[40:43], s30 sc1
  s_branch LD_15
SC_16:
  s_add_u32 s10, s10, 1
  s_cmp_gt_u32 s10, 0x20000
  s_cbranch_scc1 SD_18
  ds_read_b32 v40, v5 offset:0
  s_waitcnt lgkmcnt(0)
  s_branch SK_17
SC_19:
  s_add_u32 s10, s10, 1
  s_cmp_gt_u32 s10, 0x20000
  s_cbranch_scc1 SD_21
  buffer_load_dword v40, v12, s[40:43], s12 offen sc1
  s_waitcnt vmcnt(0)
  s_branch SK_20
SC_22:
  s_add_u32 s10, s10, 1
  s_cmp_gt_u32 s10, 0x20000
  s_cbranch_scc1 SD_24
  ds_read_b32 v42, v5 offset:4
  s_waitcnt lgkmcnt(0)
  s_branch SK_23
SC_25:
  s_add_u32 s10, s10, 1
  s_cmp_gt_u32 s10, 0x20000
  s_cbranch_scc1 SD_27
  ds_read_b32 v44, v5 offset:8
  s_waitcnt lgkmcnt(0)
  s_branch SK_26
LC_28:
  buffer_store_dwordx2 v[36:37], v16, s[40:43], s11 offen sc1
  s_branch LD_29
LC_30:
  buffer_store_dwordx2 v[36:37], v16, s[40:43], s11 offen sc1
  s_branch LD_31
SC_32:
  s_add_u32 s10, s10, 1
  s_cmp_gt_u32 s10, 0x20000
  s_cbranch_scc1 SD_34
  s_add_u32 s13, s27, 0
  buffer_load_dwordx4 v[120:123], v9, s[40:43], s13 offen offset:0 sc1
  buffer_load_dwordx4 v[124:127], v9, s[40:43], s13 offen offset:1024 sc1
  s_waitcnt vmcnt(0)
  s_branch SK_33
SC_35:
  s_add_u32 s10, s10, 1
  s_cmp_gt_u32 s10, 0x20000
  s_cbranch_scc1 SD_37
  s_add_u32 s13, s23, 0
  buffer_load_dwordx4 v[36:39], v9, s[40:43], s13 offen sc1
  s_waitcnt vmcnt(0)
  s_branch SK_36
SC_38:
  s_add_u32 s10, s10, 1
  s_cmp_gt_u32 s10, 0x20000
  s_cbranch_scc1 SD_40
  ds_read_b32 v40, v5 offset:100
  s_waitcnt lgkmcnt(0)
  s_branch SK_39
LC_41:
  buffer_store_dwordx4 v[28:31], v17, s[40:43], s11 offen sc1
  s_branch LD_42
LC_43:
  buffer_store_dwordx2 v[36:37], v16, s[40:43], s11 offen sc1
  s_branch LD_44
SC_45:
  s_add_u32 s10, s10, 1
  s_cmp_gt_u32 s10, 0x20000
  s_cbranch_scc1 SD_47
  ds_read_b32 v44, v5 offset:12
  s_waitcnt lgkmcnt(0)
  s_branch SK_46
LC_48:
  buffer_store_dword v7, off, s[40:43], s11 sc1
  s_branch LD_49
SC_50:
  s_add_u32 s10, s10, 1
  s_cmp_gt_u32 s10, 0x20000
  s_cbranch_scc1 SD_52
  ds_read_b32 v36, v5 offset:16
  s_waitcnt lgkmcnt(0)
  s_branch SK_51
SC_53:
  s_add_u32 s10, s10, 1
  s_cmp_gt_u32 s10, 0x20000
  s_cbranch_scc1 SD_55
  buffer_load_dword v36, v15, s[40:43], s14 offen sc1
  s_waitcnt vmcnt(0)
  s_branch SK_54
SC_56:
  s_add_u32 s10, s10, 1
  s_cmp_gt_u32 s10, 0x20000
  s_cbranch_scc1 SD_58
  ds_read_b32 v36, v5 offset:24
  s_waitcnt lgkmcnt(0)
  s_branch SK_57
SC_59:
  s_add_u32 s10, s10, 1
  s_cmp_gt_u32 s10, 0x20000
  s_cbranch_scc1 SD_61
  s_add_u32 s13, s27, 2883584
  buffer_load_dwordx4 v[72:75], v9, s[40:43], s13 offen offset:0 sc1
  buffer_load_dwordx4 v[76:79], v9, s[40:43], s13 offen offset:1024 sc1
  s_waitcnt vmcnt(0)
  s_branch SK_60
SC_62:
  s_add_u32 s10, s10, 1
  s_cmp_gt_u32 s10, 0x20000
  s_cbranch_scc1 SD_64
  s_add_u32 s13, s23, 131072
  buffer_load_dwordx4 v[36:39], v9, s[40:43], s13 offen sc1
  s_waitcnt vmcnt(0)
  s_branch SK_63
SC_65:
  s_add_u32 s10, s10, 1
  s_cmp_gt_u32 s10, 0x20000
  s_cbranch_scc1 SD_67
  ds_read_b32 v40, v5 offset:104
  s_waitcnt lgkmcnt(0)
  s_branch SK_66
LC_68:
  buffer_store_dwordx4 v[20:23], v17, s[40:43], s11 offen sc1
  s_branch LD_69
LC_70:
  buffer_store_dwordx2 v[36:37], v16, s[40:43], s11 offen sc1
  s_branch LD_71
LC_72:
  buffer_store_dword v7, off, s[40:43], s11 sc1
  s_branch LD_73
SC_74:
  s_add_u32 s10, s10, 1
  s_cmp_gt_u32 s10, 0x20000
  s_cbranch_scc1 SD_76
  buffer_load_dword v12, v15, s[40:43], s14 offen sc1
  s_waitcnt vmcnt(0)
  s_branch SK_75
SC_77:
  s_add_u32 s10, s10, 1
  s_cmp_gt_u32 s10, 0x20000
  s_cbranch_scc1 SD_79
  s_add_u32 s13, s23, 393216
  buffer_load_dwordx4 v[36:39], v9, s[40:43], s13 offen sc1
  s_waitcnt vmcnt(0)
  s_branch SK_78
SC_80:
  s_add_u32 s10, s10, 1
  s_cmp_gt_u32 s10, 0x20000
  s_cbranch_scc1 SD_82
  ds_read_b32 v40, v5 offset:16
  s_waitcnt lgkmcnt(0)
  s_branch SK_81
SC_84:
  s_add_u32 s10, s10, 1
  s_cmp_gt_u32 s10, 0x20000
  s_cbranch_scc1 SD_86
  buffer_load_dword v12, v15, s[40:43], s14 offen sc1
  s_waitcnt vmcnt(0)
  s_branch SK_85
SC_87:
  s_add_u32 s10, s10, 1
  s_cmp_gt_u32 s10, 0x20000
  s_cbranch_scc1 SD_89
  ds_read_b32 v3, v5 offset:48
  s_waitcnt lgkmcnt(0)
  s_branch SK_88
SC_91:
  s_add_u32 s10, s10, 1
  s_cmp_gt_u32 s10, 0x20000
  s_cbranch_scc1 SD_93
  buffer_load_dword v12, v15, s[40:43], s14 offen sc1
  s_waitcnt vmcnt(0)
  s_branch SK_92
SC_94:
  s_add_u32 s10, s10, 1
  s_cmp_gt_u32 s10, 0x20000
  s_cbranch_scc1 SD_96
  ds_read_b32 v3, v5 offset:52
  s_waitcnt lgkmcnt(0)
  s_branch SK_95
SC_97:
  s_add_u32 s10, s10, 1
  s_cmp_gt_u32 s10, 0x20000
  s_cbranch_scc1 SD_99
  ds_read_b32 v36, v5 offset:68
  s_waitcnt lgkmcnt(0)
  s_branch SK_98
LC_100:
  buffer_store_dwordx2 v[36:37], v16, s[40:43], s11 offen sc1
  s_branch LD_101
SC_102:
  s_add_u32 s10, s10, 1
  s_cmp_gt_u32 s10, 0x20000
  s_cbranch_scc1 SD_104
  s_add_u32 s13, s23, 131072
  buffer_load_dwordx4 v[36:39], v9, s[40:43], s13 offen sc1
  s_waitcnt vmcnt(0)
  s_branch SK_103
LC_105:
  buffer_store_dwordx4 v[20:23], v17, s[40:43], s11 offen sc1
  s_branch LD_106
LC_107:
  buffer_store_dwordx2 v[36:37], v16, s[40:43], s11 offen sc1
  s_branch LD_108
LC_109:
  buffer_store_dword v7, off, s[40:43], s11 sc1
  s_branch LD_110
SC_111:
  s_add_u32 s10, s10, 1
  s_cmp_gt_u32 s10, 0x20000
  s_cbranch_scc1 SD_113
  ds_read_b32 v38, v5 offset:84
  s_waitcnt lgkmcnt(0)
  s_branch SK_112
SC_114:
  s_add_u32 s10, s10, 1
  s_cmp_gt_u32 s10, 0x20000
  s_cbranch_scc1 SD_116
  buffer_load_dword v36, v15, s[40:43], s14 offen sc1
  s_waitcnt vmcnt(0)
  s_branch SK_115
SC_117:
  s_add_u32 s10, s10, 1
  s_cmp_gt_u32 s10, 0x20000
  s_cbranch_scc1 SD_119
  s_add_u32 s13, s23, 393216
  buffer_load_dwordx4 v[36:39], v9, s[40:43], s13 offen sc1
  s_waitcnt vmcnt(0)
  s_branch SK_118
SC_120:
  s_add_u32 s10, s10, 1
  s_cmp_gt_u32 s10, 0x20000
  s_cbranch_scc1 SD_122
  buffer_load_dword v12, v15, s[40:43], s14 offen sc1
  s_waitcnt vmcnt(0)
  s_branch SK_121
SC_123:
  s_add_u32 s10, s10, 1
  s_cmp_gt_u32 s10, 0x20000
  s_cbranch_scc1 SD_125
  ds_read_b32 v3, v5 offset:56
  s_waitcnt lgkmcnt(0)
  s_branch SK_124
SC_127:
  s_add_u32 s10, s10, 1
  s_cmp_gt_u32 s10, 0x20000
  s_cbranch_scc1 SD_129
  buffer_load_dword v12, v15, s[40:43], s14 offen sc1
  s_waitcnt vmcnt(0)
  s_branch SK_128
SC_130:
  s_add_u32 s10, s10, 1
  s_cmp_gt_u32 s10, 0x20000
  s_cbranch_scc1 SD_132
  ds_read_b32 v3, v5 offset:60
  s_waitcnt lgkmcnt(0)
  s_branch SK_131
SC_133:
  s_add_u32 s10, s10, 1
  s_cmp_gt_u32 s10, 0x20000
  s_cbranch_scc1 SD_135
  ds_read_b32 v36, v5 offset:76
  s_waitcnt lgkmcnt(0)
  s_branch SK_134
.p2align 6
L_G1:
  v_mov_b32 v3, 157696
  v_mov_b32 v4, 1
  s_mov_b32 s44, s30
  s_mov_b32 s45, s31
  s_mov_b32 s46, 1409024
  s_mov_b32 s47, 0x20000
  s_mov_b32 s52, s34
  s_mov_b32 s53, s35
  s_mov_b32 s54, 2097152
  s_mov_b32 s55, 0x20000
  s_mov_b32 s48, s32
  s_mov_b32 s49, s33
  s_mov_b32 s50, 1409024
  s_mov_b32 s51, 0x20000
  s_mov_b32 s40, s38
  s_mov_b32 s41, s39
  s_mov_b32 s42, 268435456
  s_mov_b32 s43, 0x20000
  s_lshr_b32 s0, s5, 3
  s_lshl_b32 s6, s4, 2
  s_add_u32 s6, s6, s0
  s_and_b32 s7, s5, 7
  s_getreg_b32 s1, hwreg(HW_REG_XCC_ID, 0, 3)
  s_or_b32 s1, s1, 0x80
  s_mul_i32 s1, s1, 0x01010101
  s_mov_b32 s61, 0x3b000000
  s_mov_b32 s62, 0x3727c5ac
  s_mov_b32 s63, 0x3f803f80
  s_lshl_b32 s11, s6, 2
  s_add_u32 s19, s11, s15
  s_lshl_b32 s19, s19, 7
  s_lshr_b32 s12, s7, 1
  s_add_u32 s11, s11, s12
  s_lshl_b32 s11, s11, 3
  s_and_b32 s12, s7, 1
  s_add_u32 s11, s11, s12
  s_lshl_b32 s11, s11, 2
  s_add_u32 s11, s11, s15
  s_lshl_b32 s18, s11, 2
  s_mul_i32 s20, s6, 90112
  s_add_u32 s20, s20, 6291456
  s_lshl_b32 s21, s6, 16
  s_add_u32 s21, s21, 2097152
  v_lshrrev_b32 v12, 2, v0
  v_and_b32 v13, 3, v0
  v_lshlrev_b32 v14, 14, v12
  v_lshl_add_u32 v14, v13, 7, v14
  s_lshl_b32 s11, s6, 9
  s_add_u32 s11, s11, 16384
  v_add_u32 v14, s11, v14
  s_lshl_b32 s11, s4, 9
  s_add_u32 s11, s11, 4096
  v_lshl_add_u32 v15, v13, 7, s11
  v_cmp_le_u32 vcc, 32, v0
  s_nop 1
  v_cndmask_b32 v14, v14, v15, vcc
  v_and_b32 v12, 3, v12
  v_lshlrev_b32 v15, 17, v12
  v_lshl_add_u32 v15, v13, 10, v15
  s_lshl_b32 s11, s6, 12
  s_lshl_b32 s12, s7, 7
  s_add_u32 s11, s11, s12
  s_add_u32 s11, s11, 1048576
  v_add_u32 v15, s11, v15
  s_cmp_eq_u32 s15, 1
  s_cselect_b64 vcc, -1, 0
  v_cndmask_b32 v14, v14, v15, vcc
  s_cmp_ge_u32 s15, 2
  s_cbranch_scc1 TCH_137
  buffer_load_dword v63, v14, s[40:43], 0 offen sc1
TCH_137:
  s_movk_i32 s13, 2979
  s_movk_i32 s14, 2752
  s_lshl_b32 s11, s15, 6
  v_add_u32 v12, s11, v0
  v_mul_lo_u32 v13, v12, s13
  v_lshrrev_b32 v13, 16, v13
  v_mul_u32_u24 v14, 22, v13
  v_sub_u32 v14, v12, v14
  v_mul_u32_u24 v56, s14, v13
  v_lshl_add_u32 v56, v14, 4, v56
  v_add_u32 v12, 256, v12
  v_mul_lo_u32 v13, v12, s13
  v_lshrrev_b32 v13, 16, v13
  v_mul_u32_u24 v14, 22, v13
  v_sub_u32 v14, v12, v14
  v_mul_u32_u24 v57, s14, v13
  v_lshl_add_u32 v57, v14, 4, v57
  v_add_u32 v12, 256, v12
  v_mul_lo_u32 v13, v12, s13
  v_lshrrev_b32 v13, 16, v13
  v_mul_u32_u24 v14, 22, v13
  v_sub_u32 v14, v12, v14
  v_mul_u32_u24 v58, s14, v13
  v_lshl_add_u32 v58, v14, 4, v58
  v_add_u32 v12, 256, v12
  v_mul_lo_u32 v13, v12, s13
  v_lshrrev_b32 v13, 16, v13
  v_mul_u32_u24 v14, 22, v13
  v_sub_u32 v14, v12, v14
  v_mul_u32_u24 v59, s14, v13
  v_lshl_add_u32 v59, v14, 4, v59
  v_add_u32 v12, 256, v12
  v_mul_lo_u32 v13, v12, s13
  v_lshrrev_b32 v13, 16, v13
  v_mul_u32_u24 v14, 22, v13
  v_sub_u32 v14, v12, v14
  v_mul_u32_u24 v60, s14, v13
  v_lshl_add_u32 v60, v14, 4, v60
  v_add_u32 v12, 256, v12
  v_mul_lo_u32 v13, v12, s13
  v_lshrrev_b32 v13, 16, v13
  v_mul_u32_u24 v14, 22, v13
  v_sub_u32 v14, v12, v14
  v_mul_u32_u24 v61, s14, v13
  v_lshl_add_u32 v61, v14, 4, v61
  s_cmp_ge_u32 s15, 2
  s_cselect_b32 s11, 2130706432, 0
  v_or_b32 v61, s11, v61
  s_mul_i32 s11, s7, 11
  s_min_u32 s11, s11, 75
  s_lshl_b32 s69, s11, 5
  s_mul_i32 s12, s15, 3
  s_add_u32 s56, s11, s12
  s_lshl_b32 s59, s15, 13
  s_lshl_b32 s68, s15, 10
  v_and_b32 v12, 3, v0
  v_bfe_u32 v13, v0, 2, 2
  s_mul_i32 s11, s15, 96
  s_movk_i32 s12, 352
  v_lshl_add_u32 v10, v2, 3, v13
  v_mul_u32_u24 v10, s12, v10
  v_lshl_add_u32 v10, v12, 3, v10
  v_add_u32 v10, s11, v10
  v_add_u32 v11, 107776, v10
  s_lshl_b32 s23, s19, 3
  s_add_u32 s23, s23, 1048576
  s_lshl_b32 s11, s7, 7
  s_add_u32 s22, s23, s11
  s_lshl_b32 s25, s19, 6
  s_add_u32 s25, s25, s11
  s_lshl_b32 s11, s7, 12
  s_add_u32 s24, s21, s11
  s_lshr_b32 s11, s15, 1
  s_lshl_b32 s11, s11, 10
  s_add_u32 s24, s24, s11
  s_and_b32 s11, s15, 1
  s_lshl_b32 s11, s11, 7
  s_add_u32 s24, s24, s11
  s_lshl_b32 s11, s7, 13
  s_add_u32 s27, s20, s11
  s_lshl_b32 s12, s15, 11
  s_add_u32 s27, s27, s12
  v_and_b32 v32, 1, v0
  v_bfe_u32 v33, v0, 1, 1
  v_bfe_u32 v34, v0, 2, 2
  v_lshl_add_u32 v35, v2, 1, v33
  v_lshl_add_u32 v35, v35, 3, v34
  s_lshl_b32 s11, s15, 4
  s_add_u32 s11, s11, 158720
  v_lshl_add_u32 v9, v35, 6, s11
  v_lshl_add_u32 v9, v32, 3, v9
  s_lshl_b32 s11, s15, 10
  s_add_u32 s11, s11, 158720
  v_lshl_add_u32 v8, v0, 3, s11
  v_lshrrev_b32 v32, 3, v0
  v_and_b32 v33, 7, v0
  v_xor_b32 v34, v32, v33
  v_bfe_u32 v35, v0, 4, 1
  v_lshl_add_u32 v34, v35, 3, v34
  s_add_u32 s12, s12, 0
  v_lshl_add_u32 v20, v33, 8, s12
  v_lshl_add_u32 v20, v34, 4, v20
  v_lshlrev_b32 v21, 4, v33
  v_lshl_add_u32 v21, v35, 3, v21
  v_lshrrev_b32 v34, 5, v0
  v_and_b32 v35, 3, v32
  v_lshlrev_b32 v22, 11, v34
  v_lshl_add_u32 v22, v35, 8, v22
  v_lshl_add_u32 v22, v33, 4, v22
  v_lshlrev_b32 v23, 10, v33
  v_lshl_add_u32 v23, v32, 4, v23
  s_lshl_b32 s11, s4, 5
  v_and_b32 v30, 7, v0
  v_lshl_add_u32 v30, v30, 2, s11
  s_waitcnt lgkmcnt(0)
  s_mul_i32 s9, s9, 1664525
  s_add_u32 s9, s9, 1013904223
  v_mov_b32 v5, s9
  ds_read_b32 v1, v3 offset:28
  s_waitcnt lgkmcnt(0)
SK_139:
  v_cmp_gt_u32 vcc, 4, v1
  s_cbranch_vccnz SC_138
SD_140:
  s_lshl_b32 s58, s0, 1
  s_add_u32 s58, s58, 0
  s_and_b32 s58, s58, 7
  s_mul_i32 s58, s58, 176128
  s_add_u32 s58, s58, s69
  s_add_u32 m0, s68, 107776
  s_nop 0
  buffer_load_dwordx4 v56, s[44:47], s58 offen lds
  s_add_u32 m0, s68, 111872
  s_nop 0
  buffer_load_dwordx4 v57, s[44:47], s58 offen lds
  s_add_u32 m0, s68, 115968
  s_nop 0
  buffer_load_dwordx4 v58, s[44:47], s58 offen lds
  s_add_u32 m0, s68, 120064
  s_nop 0
  buffer_load_dwordx4 v59, s[44:47], s58 offen lds
  s_add_u32 m0, s68, 124160
  s_nop 0
  buffer_load_dwordx4 v60, s[44:47], s58 offen lds
  s_add_u32 m0, s68, 128256
  s_nop 0
  buffer_load_dwordx4 v61, s[44:47], s58 offen lds
  s_lshl_b32 s58, s0, 1
  s_add_u32 s58, s58, 1
  s_and_b32 s58, s58, 7
  s_mul_i32 s58, s58, 176128
  s_add_u32 s58, s58, s69
  s_add_u32 m0, s68, 132352
  s_nop 0
  buffer_load_dwordx4 v56, s[44:47], s58 offen lds
  s_add_u32 m0, s68, 136448
  s_nop 0
  buffer_load_dwordx4 v57, s[44:47], s58 offen lds
  s_add_u32 m0, s68, 140544
  s_nop 0
  buffer_load_dwordx4 v58, s[44:47], s58 offen lds
  s_waitcnt vmcnt(9)
  s_bitcmp1_b32 s15, 0
  s_cbranch_scc1 HP_141
  v_mov_b32 v16, s67
  ds_read_b32 v12, v16 offset:32
  v_and_b32 v13, 7, v0
  v_lshlrev_b32 v13, 2, v13
  v_add_u32 v13, s67, v13
  v_add_u32 v14, 4160, v13
  v_cmp_gt_u32 vcc, 8, v0
  s_nop 1
  v_cndmask_b32 v13, v13, v14, vcc
  s_waitcnt lgkmcnt(0)
  v_lshlrev_b32 v12, 16, v12
  v_cmp_eq_u32 vcc, 7, v0
  s_nop 1
  v_cndmask_b32 v12, 0, v12, vcc
  s_mov_b64 exec, 0xffff
  ds_write_b32 v13, v12
  s_mov_b64 exec, -1
HP_141:
  s_mov_b64 exec, 1
  ds_add_u32 v3, v4 offset:0
  s_mov_b64 exec, -1
  ds_read_b32 v1, v3 offset:20
  s_waitcnt lgkmcnt(0)
SK_143:
  v_cmp_gt_u32 vcc, 4, v1
  s_cbranch_vccnz SC_142
SD_144:
  s_setprio 1
  global_load_dword v31, v30, s[36:37] sc1
  s_add_u32 m0, s68, 144640
  s_nop 0
  buffer_load_dwordx4 v59, s[44:47], s58 offen lds
  s_add_u32 m0, s68, 148736
  s_nop 0
  buffer_load_dwordx4 v60, s[44:47], s58 offen lds
  s_add_u32 m0, s68, 152832
  s_nop 0
  buffer_load_dwordx4 v61, s[44:47], s58 offen lds
  s_lshl_b32 s58, s0, 1
  s_add_u32 s58, s58, 2
  s_and_b32 s58, s58, 7
  s_mul_i32 s58, s58, 176128
  s_add_u32 s58, s58, s69
  s_add_u32 m0, s68, 32768
  s_nop 0
  buffer_load_dwordx4 v56, s[44:47], s58 offen lds
  s_add_u32 m0, s68, 36864
  s_nop 0
  buffer_load_dwordx4 v57, s[44:47], s58 offen lds
  s_add_u32 m0, s68, 40960
  s_nop 0
  buffer_load_dwordx4 v58, s[44:47], s58 offen lds
  s_add_u32 m0, s68, 45056
  s_nop 0
  buffer_load_dwordx4 v59, s[44:47], s58 offen lds
  s_add_u32 m0, s68, 49152
  s_nop 0
  buffer_load_dwordx4 v60, s[44:47], s58 offen lds
  s_add_u32 m0, s68, 53248
  s_nop 0
  buffer_load_dwordx4 v61, s[44:47], s58 offen lds
  s_waitcnt vmcnt(13)
  s_mov_b64 exec, 1
  ds_add_u32 v3, v4 offset:88
  s_mov_b64 exec, -1
  v_and_b32 v8, 7, v0
  v_lshlrev_b32 v8, 2, v8
  s_add_u32 s11, s0, 0
  s_and_b32 s11, s11, 3
  s_lshl_b32 s64, s11, 13
  s_add_u32 s11, s0, 1
  s_and_b32 s11, s11, 3
  s_lshl_b32 s65, s11, 13
  s_add_u32 s11, s0, 2
  s_and_b32 s11, s11, 3
  s_lshl_b32 s66, s11, 13
  s_add_u32 s11, s0, 3
  s_and_b32 s11, s11, 3
  s_lshl_b32 s67, s11, 13
  s_add_u32 s11, s56, 0
  s_lshl_b32 s11, s11, 10
  s_add_u32 s26, s11, s20
  s_add_u32 s11, s56, 1
  s_lshl_b32 s11, s11, 10
  s_add_u32 s57, s11, s20
  s_add_u32 s11, s56, 2
  s_add_u32 s12, s7, 80
  s_cmp_eq_u32 s15, 3
  s_cselect_b32 s11, s12, s11
  s_lshl_b32 s11, s11, 10
  s_add_u32 s29, s11, s20
  s_lshl_b32 s11, s15, 3
  s_add_u32 s11, s11, s7
  s_sub_u32 s11, s11, 24
  s_cmp_lt_u32 s11, 6
  s_cselect_b32 s29, 2130706432, s29
  s_lshl_b32 s11, s15, 8
  s_add_u32 s11, s11, 162816
  v_lshl_add_u32 v2, v2, 6, s11
  v_and_b32 v24, 15, v0
  v_cmp_eq_u32 vcc, 0, v24
  v_mov_b32 v25, s63
  s_nop 0
  v_cndmask_b32 v24, 0, v25, vcc
  v_mov_b32 v25, v24
  v_mov_b32 v26, v24
  v_mov_b32 v27, v24
  s_mov_b32 s60, 0
  ds_read_b32 v1, v3 offset:88
  s_waitcnt lgkmcnt(0)
SK_146:
  v_cmp_gt_u32 vcc, 4, v1
  s_cbranch_vccnz SC_145
SD_147:
  ds_read_b64_tr_b16 v[64:65], v11 offset:0
  ds_read_b64_tr_b16 v[66:67], v11 offset:1408
  ds_read_b64_tr_b16 v[68:69], v11 offset:32
  ds_read_b64_tr_b16 v[70:71], v11 offset:1440
  ds_read_b64_tr_b16 v[72:73], v11 offset:64
  ds_read_b64_tr_b16 v[74:75], v11 offset:1472
  ds_read_b64_tr_b16 v[76:77], v11 offset:11264
  ds_read_b64_tr_b16 v[78:79], v11 offset:12672
  ds_read_b64_tr_b16 v[80:81], v11 offset:11296
  ds_read_b64_tr_b16 v[82:83], v11 offset:12704
  ds_read_b64_tr_b16 v[84:85], v11 offset:11328
  ds_read_b64_tr_b16 v[86:87], v11 offset:12736
  s_waitcnt vmcnt(6)
  s_mov_b64 exec, 1
  ds_add_u32 v3, v4 offset:88
  s_mov_b64 exec, -1
  ds_read_b32 v1, v3 offset:88
  s_waitcnt lgkmcnt(0)
SK_149:
  v_cmp_gt_u32 vcc, 8, v1
  s_cbranch_vccnz SC_148
SD_150:
  ds_read_b64_tr_b16 v[88:89], v11 offset:24576
  ds_read_b64_tr_b16 v[90:91], v11 offset:25984
  ds_read_b64_tr_b16 v[92:93], v11 offset:24608
  ds_read_b64_tr_b16 v[94:95], v11 offset:26016
  ds_read_b64_tr_b16 v[96:97], v11 offset:24640
  ds_read_b64_tr_b16 v[98:99], v11 offset:26048
  ds_read_b64_tr_b16 v[100:101], v11 offset:35840
  ds_read_b64_tr_b16 v[102:103], v11 offset:37248
  ds_read_b64_tr_b16 v[104:105], v11 offset:35872
  ds_read_b64_tr_b16 v[106:107], v11 offset:37280
  ds_read_b64_tr_b16 v[108:109], v11 offset:35904
  ds_read_b64_tr_b16 v[110:111], v11 offset:37312
  s_lshl_b32 s58, s0, 1
  s_add_u32 s58, s58, 3
  s_and_b32 s58, s58, 7
  s_mul_i32 s58, s58, 176128
  s_add_u32 s58, s58, s69
  s_add_u32 m0, s68, 107776
  s_nop 0
  buffer_load_dwordx4 v56, s[44:47], s58 offen lds
  s_add_u32 m0, s68, 111872
  s_nop 0
  buffer_load_dwordx4 v57, s[44:47], s58 offen lds
  s_add_u32 m0, s68, 115968
  s_nop 0
  buffer_load_dwordx4 v58, s[44:47], s58 offen lds
  s_waitcnt vmcnt(3)
  s_mov_b64 exec, 1
  ds_add_u32 v3, v4 offset:88
  s_mov_b64 exec, -1
  s_add_u32 m0, s68, 120064
  s_nop 0
  buffer_load_dwordx4 v59, s[44:47], s58 offen lds
  s_add_u32 m0, s68, 124160
  s_nop 0
  buffer_load_dwordx4 v60, s[44:47], s58 offen lds
  s_add_u32 m0, s68, 128256
  s_nop 0
  buffer_load_dwordx4 v61, s[44:47], s58 offen lds
  ds_read_b32 v1, v3 offset:88
  s_waitcnt lgkmcnt(0)
SK_152:
  v_cmp_gt_u32 vcc, 12, v1
  s_cbranch_vccnz SC_151
SD_153:
  ds_read_b64_tr_b16 v[112:113], v10 offset:32768
  ds_read_b64_tr_b16 v[114:115], v10 offset:34176
  ds_read_b64_tr_b16 v[116:117], v10 offset:32800
  ds_read_b64_tr_b16 v[118:119], v10 offset:34208
  ds_read_b64_tr_b16 v[120:121], v10 offset:32832
  ds_read_b64_tr_b16 v[122:123], v10 offset:34240
  ds_read_b64_tr_b16 v[124:125], v10 offset:44032
  ds_read_b64_tr_b16 v[126:127], v10 offset:45440
  ds_read_b64_tr_b16 v[128:129], v10 offset:44064
  ds_read_b64_tr_b16 v[130:131], v10 offset:45472
  ds_read_b64_tr_b16 v[132:133], v10 offset:44096
  ds_read_b64_tr_b16 v[134:135], v10 offset:45504
  s_lshl_b32 s58, s0, 1
  s_add_u32 s58, s58, 4
  s_and_b32 s58, s58, 7
  s_mul_i32 s58, s58, 176128
  s_add_u32 s58, s58, s69
  s_add_u32 m0, s68, 132352
  s_nop 0
  buffer_load_dwordx4 v56, s[44:47], s58 offen lds
  s_add_u32 m0, s68, 136448
  s_nop 0
  buffer_load_dwordx4 v57, s[44:47], s58 offen lds
  s_add_u32 m0, s68, 140544
  s_nop 0
  buffer_load_dwordx4 v58, s[44:47], s58 offen lds
  s_waitcnt vmcnt(3)
  s_mov_b64 exec, 1
  ds_add_u32 v3, v4 offset:88
  s_mov_b64 exec, -1
  s_add_u32 m0, s68, 144640
  s_nop 0
  buffer_load_dwordx4 v59, s[44:47], s58 offen lds
  s_add_u32 m0, s68, 148736
  s_nop 0
  buffer_load_dwordx4 v60, s[44:47], s58 offen lds
  s_add_u32 m0, s68, 152832
  s_nop 0
  buffer_load_dwordx4 v61, s[44:47], s58 offen lds
  ds_read_b32 v1, v3 offset:88
  s_waitcnt lgkmcnt(0)
SK_155:
  v_cmp_gt_u32 vcc, 16, v1
  s_cbranch_vccnz SC_154
SD_156:
  ds_read_b64_tr_b16 v[136:137], v11 offset:0
  ds_read_b64_tr_b16 v[138:139], v11 offset:1408
  ds_read_b64_tr_b16 v[140:141], v11 offset:32
  ds_read_b64_tr_b16 v[142:143], v11 offset:1440
  ds_read_b64_tr_b16 v[144:145], v11 offset:64
  ds_read_b64_tr_b16 v[146:147], v11 offset:1472
  ds_read_b64_tr_b16 v[148:149], v11 offset:11264
  ds_read_b64_tr_b16 v[150:151], v11 offset:12672
  ds_read_b64_tr_b16 v[152:153], v11 offset:11296
  ds_read_b64_tr_b16 v[154:155], v11 offset:12704
  ds_read_b64_tr_b16 v[156:157], v11 offset:11328
  ds_read_b64_tr_b16 v[158:159], v11 offset:12736
  s_lshl_b32 s58, s0, 1
  s_add_u32 s58, s58, 5
  s_and_b32 s58, s58, 7
  s_mul_i32 s58, s58, 176128
  s_add_u32 s58, s58, s69
  s_add_u32 m0, s68, 32768
  s_nop 0
  buffer_load_dwordx4 v56, s[44:47], s58 offen lds
  s_add_u32 m0, s68, 36864
  s_nop 0
  buffer_load_dwordx4 v57, s[44:47], s58 offen lds
  s_add_u32 m0, s68, 40960
  s_nop 0
  buffer_load_dwordx4 v58, s[44:47], s58 offen lds
  s_waitcnt vmcnt(3)
  s_mov_b64 exec, 1
  ds_add_u32 v3, v4 offset:88
  s_mov_b64 exec, -1
  s_add_u32 m0, s68, 45056
  s_nop 0
  buffer_load_dwordx4 v59, s[44:47], s58 offen lds
  s_add_u32 m0, s68, 49152
  s_nop 0
  buffer_load_dwordx4 v60, s[44:47], s58 offen lds
  s_add_u32 m0, s68, 53248
  s_nop 0
  buffer_load_dwordx4 v61, s[44:47], s58 offen lds
  ds_read_b32 v1, v3 offset:88
  s_waitcnt lgkmcnt(0)
SK_158:
  v_cmp_gt_u32 vcc, 20, v1
  s_cbranch_vccnz SC_157
SD_159:
  ds_read_b64_tr_b16 v[160:161], v11 offset:24576
  ds_read_b64_tr_b16 v[162:163], v11 offset:25984
  ds_read_b64_tr_b16 v[164:165], v11 offset:24608
  ds_read_b64_tr_b16 v[166:167], v11 offset:26016
  ds_read_b64_tr_b16 v[168:169], v11 offset:24640
  ds_read_b64_tr_b16 v[170:171], v11 offset:26048
  ds_read_b64_tr_b16 v[172:173], v11 offset:35840
  ds_read_b64_tr_b16 v[174:175], v11 offset:37248
  ds_read_b64_tr_b16 v[176:177], v11 offset:35872
  ds_read_b64_tr_b16 v[178:179], v11 offset:37280
  ds_read_b64_tr_b16 v[180:181], v11 offset:35904
  ds_read_b64_tr_b16 v[182:183], v11 offset:37312
  s_lshl_b32 s58, s0, 1
  s_add_u32 s58, s58, 6
  s_and_b32 s58, s58, 7
  s_mul_i32 s58, s58, 176128
  s_add_u32 s58, s58, s69
  s_add_u32 m0, s68, 107776
  s_nop 0
  buffer_load_dwordx4 v56, s[44:47], s58 offen lds
  s_add_u32 m0, s68, 111872
  s_nop 0
  buffer_load_dwordx4 v57, s[44:47], s58 offen lds
  s_add_u32 m0, s68, 115968
  s_nop 0
  buffer_load_dwordx4 v58, s[44:47], s58 offen lds
  s_waitcnt vmcnt(3)
  s_mov_b64 exec, 1
  ds_add_u32 v3, v4 offset:88
  s_mov_b64 exec, -1
  s_add_u32 m0, s68, 120064
  s_nop 0
  buffer_load_dwordx4 v59, s[44:47], s58 offen lds
  s_add_u32 m0, s68, 124160
  s_nop 0
  buffer_load_dwordx4 v60, s[44:47], s58 offen lds
  s_add_u32 m0, s68, 128256
  s_nop 0
  buffer_load_dwordx4 v61, s[44:47], s58 offen lds
  ds_read_b32 v1, v3 offset:88
  s_waitcnt lgkmcnt(0)
SK_161:
  v_cmp_gt_u32 vcc, 24, v1
  s_cbranch_vccnz SC_160
SD_162:
  ds_read_b64_tr_b16 v[184:185], v10 offset:32768
  ds_read_b64_tr_b16 v[186:187], v10 offset:34176
  ds_read_b64_tr_b16 v[188:189], v10 offset:32800
  ds_read_b64_tr_b16 v[190:191], v10 offset:34208
  ds_read_b64_tr_b16 v[192:193], v10 offset:32832
  ds_read_b64_tr_b16 v[194:195], v10 offset:34240
  ds_read_b64_tr_b16 v[196:197], v10 offset:44032
  ds_read_b64_tr_b16 v[198:199], v10 offset:45440
  ds_read_b64_tr_b16 v[200:201], v10 offset:44064
  ds_read_b64_tr_b16 v[202:203], v10 offset:45472
  ds_read_b64_tr_b16 v[204:205], v10 offset:44096
  ds_read_b64_tr_b16 v[206:207], v10 offset:45504
  s_lshl_b32 s58, s0, 1
  s_add_u32 s58, s58, 7
  s_and_b32 s58, s58, 7
  s_mul_i32 s58, s58, 176128
  s_add_u32 s58, s58, s69
  s_add_u32 m0, s68, 132352
  s_nop 0
  buffer_load_dwordx4 v56, s[44:47], s58 offen lds
  s_add_u32 m0, s68, 136448
  s_nop 0
  buffer_load_dwordx4 v57, s[44:47], s58 offen lds
  s_add_u32 m0, s68, 140544
  s_nop 0
  buffer_load_dwordx4 v58, s[44:47], s58 offen lds
  s_waitcnt vmcnt(3)
  s_mov_b64 exec, 1
  ds_add_u32 v3, v4 offset:88
  s_mov_b64 exec, -1
  s_add_u32 m0, s68, 144640
  s_nop 0
  buffer_load_dwordx4 v59, s[44:47], s58 offen lds
  s_add_u32 m0, s68, 148736
  s_nop 0
  buffer_load_dwordx4 v60, s[44:47], s58 offen lds
  s_add_u32 m0, s68, 152832
  s_nop 0
  buffer_load_dwordx4 v61, s[44:47], s58 offen lds
  ds_read_b32 v1, v3 offset:88
  s_waitcnt lgkmcnt(0)
SK_164:
  v_cmp_gt_u32 vcc, 28, v1
  s_cbranch_vccnz SC_163
SD_165:
  ds_read_b64_tr_b16 v[208:209], v11 offset:0
  ds_read_b64_tr_b16 v[210:211], v11 offset:1408
  ds_read_b64_tr_b16 v[212:213], v11 offset:32
  ds_read_b64_tr_b16 v[214:215], v11 offset:1440
  ds_read_b64_tr_b16 v[216:217], v11 offset:64
  ds_read_b64_tr_b16 v[218:219], v11 offset:1472
  ds_read_b64_tr_b16 v[220:221], v11 offset:11264
  ds_read_b64_tr_b16 v[222:223], v11 offset:12672
  ds_read_b64_tr_b16 v[224:225], v11 offset:11296
  ds_read_b64_tr_b16 v[226:227], v11 offset:12704
  ds_read_b64_tr_b16 v[228:229], v11 offset:11328
  ds_read_b64_tr_b16 v[230:231], v11 offset:12736
  s_waitcnt vmcnt(0)
  s_mov_b64 exec, 1
  ds_add_u32 v3, v4 offset:88
  s_mov_b64 exec, -1
  ds_read_b32 v1, v3 offset:88
  s_waitcnt lgkmcnt(0)
SK_167:
  v_cmp_gt_u32 vcc, 32, v1
  s_cbranch_vccnz SC_166
SD_168:
  ds_read_b64_tr_b16 v[232:233], v11 offset:24576
  ds_read_b64_tr_b16 v[234:235], v11 offset:25984
  ds_read_b64_tr_b16 v[236:237], v11 offset:24608
  ds_read_b64_tr_b16 v[238:239], v11 offset:26016
  ds_read_b64_tr_b16 v[240:241], v11 offset:24640
  ds_read_b64_tr_b16 v[242:243], v11 offset:26048
  ds_read_b64_tr_b16 v[244:245], v11 offset:35840
  ds_read_b64_tr_b16 v[246:247], v11 offset:37248
  ds_read_b64_tr_b16 v[248:249], v11 offset:35872
  ds_read_b64_tr_b16 v[250:251], v11 offset:37280
  ds_read_b64_tr_b16 v[252:253], v11 offset:35904
  ds_read_b64_tr_b16 v[254:255], v11 offset:37312
  s_mov_b32 s11, 0
MK_170:
  s_mov_b32 s28, 32
  v_cmp_ne_u32 vcc, s1, v31
  s_cbranch_vccnz MC_169
MD_171:
  s_waitcnt lgkmcnt(0)
  v_and_b32 v10, 15, v0
  v_lshlrev_b32 v10, 2, v10
  v_add_u32 v10, 157824, v10
  s_setprio 2
  s_mov_b64 exec, 1
  ds_add_u32 v3, v4 offset:24
  s_mov_b64 exec, -1
  s_cmp_lg_u32 s15, 3
  s_cbranch_scc1 ONES_172
  v_mov_b32 v72, v24
  v_mov_b32 v73, v24
  v_mov_b32 v74, v24
  v_mov_b32 v75, v24
  v_mov_b32 v84, v24
  v_mov_b32 v85, v24
  v_mov_b32 v86, v24
  v_mov_b32 v87, v24
ONES_172:
  v_mfma_f32_16x16x32_bf16 v[40:43], v[64:67], v[24:27], 0
  v_mfma_f32_16x16x32_bf16 v[44:47], v[68:71], v[24:27], 0
  v_mfma_f32_16x16x32_bf16 v[48:51], v[72:75], v[24:27], 0
  v_mfma_f32_16x16x32_bf16 v[40:43], v[76:79], v[24:27], v[40:43]
  v_mfma_f32_16x16x32_bf16 v[44:47], v[80:83], v[24:27], v[44:47]
  v_mfma_f32_16x16x32_bf16 v[48:51], v[84:87], v[24:27], v[48:51]
  s_cmp_lg_u32 s15, 3
  s_cbranch_scc1 ONES_173
  v_mov_b32 v96, v24
  v_mov_b32 v97, v24
  v_mov_b32 v98, v24
  v_mov_b32 v99, v24
  v_mov_b32 v108, v24
  v_mov_b32 v109, v24
  v_mov_b32 v110, v24
  v_mov_b32 v111, v24
ONES_173:
  v_mfma_f32_16x16x32_bf16 v[40:43], v[88:91], v[24:27], v[40:43]
  v_mfma_f32_16x16x32_bf16 v[44:47], v[92:95], v[24:27], v[44:47]
  v_mfma_f32_16x16x32_bf16 v[48:51], v[96:99], v[24:27], v[48:51]
  v_mfma_f32_16x16x32_bf16 v[40:43], v[100:103], v[24:27], v[40:43]
  v_mfma_f32_16x16x32_bf16 v[44:47], v[104:107], v[24:27], v[44:47]
  v_mfma_f32_16x16x32_bf16 v[48:51], v[108:111], v[24:27], v[48:51]
  s_cmp_lg_u32 s15, 3
  s_cbranch_scc1 ONES_174
  v_mov_b32 v120, v24
  v_mov_b32 v121, v24
  v_mov_b32 v122, v24
  v_mov_b32 v123, v24
  v_mov_b32 v132, v24
  v_mov_b32 v133, v24
  v_mov_b32 v134, v24
  v_mov_b32 v135, v24
ONES_174:
  v_mfma_f32_16x16x32_bf16 v[40:43], v[112:115], v[24:27], v[40:43]
  v_mfma_f32_16x16x32_bf16 v[44:47], v[116:119], v[24:27], v[44:47]
  v_mfma_f32_16x16x32_bf16 v[48:51], v[120:123], v[24:27], v[48:51]
  v_mfma_f32_16x16x32_bf16 v[40:43], v[124:127], v[24:27], v[40:43]
  v_mfma_f32_16x16x32_bf16 v[44:47], v[128:131], v[24:27], v[44:47]
  v_mfma_f32_16x16x32_bf16 v[48:51], v[132:135], v[24:27], v[48:51]
  s_cmp_lg_u32 s15, 3
  s_cbranch_scc1 ONES_175
  v_mov_b32 v144, v24
  v_mov_b32 v145, v24
  v_mov_b32 v146, v24
  v_mov_b32 v147, v24
  v_mov_b32 v156, v24
  v_mov_b32 v157, v24
  v_mov_b32 v158, v24
  v_mov_b32 v159, v24
ONES_175:
  v_mfma_f32_16x16x32_bf16 v[40:43], v[136:139], v[24:27], v[40:43]
  v_mfma_f32_16x16x32_bf16 v[44:47], v[140:143], v[24:27], v[44:47]
  v_mfma_f32_16x16x32_bf16 v[48:51], v[144:147], v[24:27], v[48:51]
  v_mfma_f32_16x16x32_bf16 v[40:43], v[148:151], v[24:27], v[40:43]
  v_mfma_f32_16x16x32_bf16 v[44:47], v[152:155], v[24:27], v[44:47]
  v_mfma_f32_16x16x32_bf16 v[48:51], v[156:159], v[24:27], v[48:51]
  s_cmp_lg_u32 s15, 3
  s_cbranch_scc1 ONES_176
  v_mov_b32 v168, v24
  v_mov_b32 v169, v24
  v_mov_b32 v170, v24
  v_mov_b32 v171, v24
  v_mov_b32 v180, v24
  v_mov_b32 v181, v24
  v_mov_b32 v182, v24
  v_mov_b32 v183, v24
ONES_176:
  v_mfma_f32_16x16x32_bf16 v[40:43], v[160:163], v[24:27], v[40:43]
  v_mfma_f32_16x16x32_bf16 v[44:47], v[164:167], v[24:27], v[44:47]
  v_mfma_f32_16x16x32_bf16 v[48:51], v[168:171], v[24:27], v[48:51]
  v_mfma_f32_16x16x32_bf16 v[40:43], v[172:175], v[24:27], v[40:43]
  v_mfma_f32_16x16x32_bf16 v[44:47], v[176:179], v[24:27], v[44:47]
  v_mfma_f32_16x16x32_bf16 v[48:51], v[180:183], v[24:27], v[48:51]
  s_cmp_lg_u32 s15, 3
  s_cbranch_scc1 ONES_177
  v_mov_b32 v192, v24
  v_mov_b32 v193, v24
  v_mov_b32 v194, v24
  v_mov_b32 v195, v24
  v_mov_b32 v204, v24
  v_mov_b32 v205, v24
  v_mov_b32 v206, v24
  v_mov_b32 v207, v24
ONES_177:
  v_mfma_f32_16x16x32_bf16 v[40:43], v[184:187], v[24:27], v[40:43]
  v_mfma_f32_16x16x32_bf16 v[44:47], v[188:191], v[24:27], v[44:47]
  v_mfma_f32_16x16x32_bf16 v[48:51], v[192:195], v[24:27], v[48:51]
  v_mfma_f32_16x16x32_bf16 v[40:43], v[196:199], v[24:27], v[40:43]
  v_mfma_f32_16x16x32_bf16 v[44:47], v[200:203], v[24:27], v[44:47]
  v_mfma_f32_16x16x32_bf16 v[48:51], v[204:207], v[24:27], v[48:51]
  s_cmp_lg_u32 s15, 3
  s_cbranch_scc1 ONES_178
  v_mov_b32 v216, v24
  v_mov_b32 v217, v24
  v_mov_b32 v218, v24
  v_mov_b32 v219, v24
  v_mov_b32 v228, v24
  v_mov_b32 v229, v24
  v_mov_b32 v230, v24
  v_mov_b32 v231, v24
ONES_178:
  v_mfma_f32_16x16x32_bf16 v[40:43], v[208:211], v[24:27], v[40:43]
  v_mfma_f32_16x16x32_bf16 v[44:47], v[212:215], v[24:27], v[44:47]
  v_mfma_f32_16x16x32_bf16 v[48:51], v[216:219], v[24:27], v[48:51]
  v_mfma_f32_16x16x32_bf16 v[40:43], v[220:223], v[24:27], v[40:43]
  v_mfma_f32_16x16x32_bf16 v[44:47], v[224:227], v[24:27], v[44:47]
  v_mfma_f32_16x16x32_bf16 v[48:51], v[228:231], v[24:27], v[48:51]
  s_cmp_lg_u32 s15, 3
  s_cbranch_scc1 ONES_179
  v_mov_b32 v240, v24
  v_mov_b32 v241, v24
  v_mov_b32 v242, v24
  v_mov_b32 v243, v24
  v_mov_b32 v252, v24
  v_mov_b32 v253, v24
  v_mov_b32 v254, v24
  v_mov_b32 v255, v24
ONES_179:
  v_mfma_f32_16x16x32_bf16 v[40:43], v[232:235], v[24:27], v[40:43]
  v_mfma_f32_16x16x32_bf16 v[44:47], v[236:239], v[24:27], v[44:47]
  v_mfma_f32_16x16x32_bf16 v[48:51], v[240:243], v[24:27], v[48:51]
  v_mfma_f32_16x16x32_bf16 v[40:43], v[244:247], v[24:27], v[40:43]
  v_mfma_f32_16x16x32_bf16 v[44:47], v[248:251], v[24:27], v[44:47]
  v_mfma_f32_16x16x32_bf16 v[48:51], v[252:255], v[24:27], v[48:51]
  s_mov_b32 s11, 0xbb000000
  s_nop 4
  v_mul_f32 v40, s11, v40
  v_mul_f32 v41, s11, v41
  v_mul_f32 v42, s11, v42
  v_mul_f32 v43, s11, v43
  v_mul_f32 v44, s11, v44
  v_mul_f32 v45, s11, v45
  v_mul_f32 v46, s11, v46
  v_mul_f32 v47, s11, v47
  v_mul_f32 v48, s11, v48
  v_mul_f32 v49, s11, v49
  v_mul_f32 v50, s11, v50
  v_mul_f32 v51, s11, v51
  s_mov_b32 exec_lo, 0x10001
  s_mov_b32 exec_hi, 0x10001
  ds_write_b128 v2, v[40:43] offset:0
  ds_write_b128 v2, v[44:47] offset:16
  ds_write_b128 v2, v[48:51] offset:32
  s_mov_b64 exec, -1
  v_add_u32 v11, s64, v7
  ds_read_b32 v1, v3 offset:32
  s_waitcnt lgkmcnt(0)
SK_181:
  v_cmp_gt_u32 vcc, 4, v1
  s_cbranch_vccnz SC_180
SD_182:
  s_sub_u32 s11, s24, s21
  v_add_u32 v1, s11, v22
  ds_read_b128 v[12:15], v1 offset:0
  ds_read_b64_tr_b16 v[16:17], v9 offset:0
  ds_read_b64_tr_b16 v[18:19], v9 offset:256
  ds_read_b128 v[24:27], v11 offset:0
  ds_read_b128 v[28:31], v11 offset:1024
  ds_read_b128 v[32:35], v11 offset:2048
  ds_read_b128 v[36:39], v11 offset:3072
  s_waitcnt lgkmcnt(2)
  v_mfma_f32_16x16x32_bf16 v[40:43], v[64:67], v[24:27], 0
  v_mfma_f32_16x16x32_bf16 v[48:51], v[68:71], v[24:27], 0
  v_mfma_f32_16x16x32_bf16 v[56:59], v[72:75], v[24:27], 0
  ds_read_b128 v[24:27], v11 offset:4096
  v_mfma_f32_16x16x32_bf16 v[44:47], v[64:67], v[28:31], 0
  v_mfma_f32_16x16x32_bf16 v[52:55], v[68:71], v[28:31], 0
  v_mfma_f32_16x16x32_bf16 v[60:63], v[72:75], v[28:31], 0
  ds_read_b128 v[28:31], v11 offset:5120
  s_waitcnt lgkmcnt(2)
  v_mfma_f32_16x16x32_bf16 v[40:43], v[76:79], v[32:35], v[40:43]
  v_mfma_f32_16x16x32_bf16 v[48:51], v[80:83], v[32:35], v[48:51]
  v_mfma_f32_16x16x32_bf16 v[56:59], v[84:87], v[32:35], v[56:59]
  ds_read_b128 v[32:35], v11 offset:6144
  v_mfma_f32_16x16x32_bf16 v[44:47], v[76:79], v[36:39], v[44:47]
  v_mfma_f32_16x16x32_bf16 v[52:55], v[80:83], v[36:39], v[52:55]
  v_mfma_f32_16x16x32_bf16 v[60:63], v[84:87], v[36:39], v[60:63]
  ds_read_b128 v[36:39], v11 offset:7168
  s_waitcnt lgkmcnt(2)
  v_mfma_f32_16x16x32_bf16 v[40:43], v[88:91], v[24:27], v[40:43]
  v_mfma_f32_16x16x32_bf16 v[48:51], v[92:95], v[24:27], v[48:51]
  v_mfma_f32_16x16x32_bf16 v[56:59], v[96:99], v[24:27], v[56:59]
  v_add_u32 v11, s65, v7
  ds_read_b128 v[24:27], v11 offset:0
  v_mfma_f32_16x16x32_bf16 v[44:47], v[88:91], v[28:31], v[44:47]
  v_mfma_f32_16x16x32_bf16 v[52:55], v[92:95], v[28:31], v[52:55]
  v_mfma_f32_16x16x32_bf16 v[60:63], v[96:99], v[28:31], v[60:63]
  ds_read_b128 v[28:31], v11 offset:1024
  s_waitcnt lgkmcnt(2)
  v_mfma_f32_16x16x32_bf16 v[40:43], v[100:103], v[32:35], v[40:43]
  v_mfma_f32_16x16x32_bf16 v[48:51], v[104:107], v[32:35], v[48:51]
  v_mfma_f32_16x16x32_bf16 v[56:59], v[108:111], v[32:35], v[56:59]
  ds_read_b128 v[32:35], v11 offset:2048
  v_mfma_f32_16x16x32_bf16 v[44:47], v[100:103], v[36:39], v[44:47]
  v_mfma_f32_16x16x32_bf16 v[52:55], v[104:107], v[36:39], v[52:55]
  v_mfma_f32_16x16x32_bf16 v[60:63], v[108:111], v[36:39], v[60:63]
  ds_read_b128 v[36:39], v11 offset:3072
  s_waitcnt lgkmcnt(2)
  v_mfma_f32_16x16x32_bf16 v[40:43], v[112:115], v[24:27], v[40:43]
  v_mfma_f32_16x16x32_bf16 v[48:51], v[116:119], v[24:27], v[48:51]
  v_mfma_f32_16x16x32_bf16 v[56:59], v[120:123], v[24:27], v[56:59]
  ds_read_b128 v[24:27], v11 offset:4096
  v_mfma_f32_16x16x32_bf16 v[44:47], v[112:115], v[28:31], v[44:47]
  v_mfma_f32_16x16x32_bf16 v[52:55], v[116:119], v[28:31], v[52:55]
  v_mfma_f32_16x16x32_bf16 v[60:63], v[120:123], v[28:31], v[60:63]
  ds_read_b128 v[28:31], v11 offset:5120
  s_waitcnt lgkmcnt(2)
  v_mfma_f32_16x16x32_bf16 v[40:43], v[124:127], v[32:35], v[40:43]
  v_mfma_f32_16x16x32_bf16 v[48:51], v[128:131], v[32:35], v[48:51]
  v_mfma_f32_16x16x32_bf16 v[56:59], v[132:135], v[32:35], v[56:59]
  ds_read_b128 v[32:35], v11 offset:6144
  v_mfma_f32_16x16x32_bf16 v[44:47], v[124:127], v[36:39], v[44:47]
  v_mfma_f32_16x16x32_bf16 v[52:55], v[128:131], v[36:39], v[52:55]
  v_mfma_f32_16x16x32_bf16 v[60:63], v[132:135], v[36:39], v[60:63]
  ds_read_b128 v[36:39], v11 offset:7168
  s_waitcnt lgkmcnt(2)
  v_mfma_f32_16x16x32_bf16 v[40:43], v[136:139], v[24:27], v[40:43]
  v_mfma_f32_16x16x32_bf16 v[48:51], v[140:143], v[24:27], v[48:51]
  v_mfma_f32_16x16x32_bf16 v[56:59], v[144:147], v[24:27], v[56:59]
  v_add_u32 v11, s66, v7
  ds_read_b128 v[24:27], v11 offset:0
  v_mfma_f32_16x16x32_bf16 v[44:47], v[136:139], v[28:31], v[44:47]
  v_mfma_f32_16x16x32_bf16 v[52:55], v[140:143], v[28:31], v[52:55]
  v_mfma_f32_16x16x32_bf16 v[60:63], v[144:147], v[28:31], v[60:63]
  ds_read_b128 v[28:31], v11 offset:1024
  s_waitcnt lgkmcnt(2)
  v_mfma_f32_16x16x32_bf16 v[40:43], v[148:151], v[32:35], v[40:43]
  v_mfma_f32_16x16x32_bf16 v[48:51], v[152:155], v[32:35], v[48:51]
  v_mfma_f32_16x16x32_bf16 v[56:59], v[156:159], v[32:35], v[56:59]
  ds_read_b128 v[32:35], v11 offset:2048
  v_mfma_f32_16x16x32_bf16 v[44:47], v[148:151], v[36:39], v[44:47]
  v_mfma_f32_16x16x32_bf16 v[52:55], v[152:155], v[36:39], v[52:55]
  v_mfma_f32_16x16x32_bf16 v[60:63], v[156:159], v[36:39], v[60:63]
  ds_read_b128 v[36:39], v11 offset:3072
  s_waitcnt lgkmcnt(2)
  v_mfma_f32_16x16x32_bf16 v[40:43], v[160:163], v[24:27], v[40:43]
  v_mfma_f32_16x16x32_bf16 v[48:51], v[164:167], v[24:27], v[48:51]
  v_mfma_f32_16x16x32_bf16 v[56:59], v[168:171], v[24:27], v[56:59]
  ds_read_b128 v[24:27], v11 offset:4096
  v_mfma_f32_16x16x32_bf16 v[44:47], v[160:163], v[28:31], v[44:47]
  v_mfma_f32_16x16x32_bf16 v[52:55], v[164:167], v[28:31], v[52:55]
  v_mfma_f32_16x16x32_bf16 v[60:63], v[168:171], v[28:31], v[60:63]
  ds_read_b128 v[28:31], v11 offset:5120
  s_waitcnt lgkmcnt(2)
  v_mfma_f32_16x16x32_bf16 v[40:43], v[172:175], v[32:35], v[40:43]
  v_mfma_f32_16x16x32_bf16 v[48:51], v[176:179], v[32:35], v[48:51]
  v_mfma_f32_16x16x32_bf16 v[56:59], v[180:183], v[32:35], v[56:59]
  ds_read_b128 v[32:35], v11 offset:6144
  v_mfma_f32_16x16x32_bf16 v[44:47], v[172:175], v[36:39], v[44:47]
  v_mfma_f32_16x16x32_bf16 v[52:55], v[176:179], v[36:39], v[52:55]
  v_mfma_f32_16x16x32_bf16 v[60:63], v[180:183], v[36:39], v[60:63]
  ds_read_b128 v[36:39], v11 offset:7168
  s_waitcnt lgkmcnt(2)
  v_mfma_f32_16x16x32_bf16 v[40:43], v[184:187], v[24:27], v[40:43]
  v_mfma_f32_16x16x32_bf16 v[48:51], v[188:191], v[24:27], v[48:51]
  v_mfma_f32_16x16x32_bf16 v[56:59], v[192:195], v[24:27], v[56:59]
  v_add_u32 v11, s67, v7
  ds_read_b128 v[24:27], v11 offset:0
  v_mfma_f32_16x16x32_bf16 v[44:47], v[184:187], v[28:31], v[44:47]
  v_mfma_f32_16x16x32_bf16 v[52:55], v[188:191], v[28:31], v[52:55]
  v_mfma_f32_16x16x32_bf16 v[60:63], v[192:195], v[28:31], v[60:63]
  ds_read_b128 v[28:31], v11 offset:1024
  s_waitcnt lgkmcnt(2)
  v_mfma_f32_16x16x32_bf16 v[40:43], v[196:199], v[32:35], v[40:43]
  v_mfma_f32_16x16x32_bf16 v[48:51], v[200:203], v[32:35], v[48:51]
  v_mfma_f32_16x16x32_bf16 v[56:59], v[204:207], v[32:35], v[56:59]
  ds_read_b128 v[32:35], v11 offset:2048
  v_mfma_f32_16x16x32_bf16 v[44:47], v[196:199], v[36:39], v[44:47]
  v_mfma_f32_16x16x32_bf16 v[52:55], v[200:203], v[36:39], v[52:55]
  v_mfma_f32_16x16x32_bf16 v[60:63], v[204:207], v[36:39], v[60:63]
  ds_read_b128 v[36:39], v11 offset:3072
  s_waitcnt lgkmcnt(2)
  v_mfma_f32_16x16x32_bf16 v[40:43], v[208:211], v[24:27], v[40:43]
  v_mfma_f32_16x16x32_bf16 v[48:51], v[212:215], v[24:27], v[48:51]
  v_mfma_f32_16x16x32_bf16 v[56:59], v[216:219], v[24:27], v[56:59]
  ds_read_b128 v[24:27], v11 offset:4096
  v_mfma_f32_16x16x32_bf16 v[44:47], v[208:211], v[28:31], v[44:47]
  v_mfma_f32_16x16x32_bf16 v[52:55], v[212:215], v[28:31], v[52:55]
  v_mfma_f32_16x16x32_bf16 v[60:63], v[216:219], v[28:31], v[60:63]
  ds_read_b128 v[28:31], v11 offset:5120
  s_waitcnt lgkmcnt(2)
  v_mfma_f32_16x16x32_bf16 v[40:43], v[220:223], v[32:35], v[40:43]
  v_mfma_f32_16x16x32_bf16 v[48:51], v[224:227], v[32:35], v[48:51]
  v_mfma_f32_16x16x32_bf16 v[56:59], v[228:231], v[32:35], v[56:59]
  ds_read_b128 v[32:35], v11 offset:6144
  v_mfma_f32_16x16x32_bf16 v[44:47], v[220:223], v[36:39], v[44:47]
  v_mfma_f32_16x16x32_bf16 v[52:55], v[224:227], v[36:39], v[52:55]
  v_mfma_f32_16x16x32_bf16 v[60:63], v[228:231], v[36:39], v[60:63]
  ds_read_b128 v[36:39], v11 offset:7168
  s_waitcnt lgkmcnt(3)
  v_mfma_f32_16x16x32_bf16 v[56:59], v[240:243], v[24:27], v[56:59]
  s_waitcnt lgkmcnt(2)
  v_mfma_f32_16x16x32_bf16 v[60:63], v[240:243], v[28:31], v[60:63]
  s_waitcnt lgkmcnt(1)
  v_mfma_f32_16x16x32_bf16 v[56:59], v[252:255], v[32:35], v[56:59]
  s_waitcnt lgkmcnt(0)
  v_mfma_f32_16x16x32_bf16 v[60:63], v[252:255], v[36:39], v[60:63]
  s_mov_b64 exec, 1
  ds_add_u32 v3, v4 offset:48
  s_mov_b64 exec, -1
  v_mfma_f32_16x16x32_bf16 v[40:43], v[232:235], v[24:27], v[40:43]
  v_mfma_f32_16x16x32_bf16 v[48:51], v[236:239], v[24:27], v[48:51]
  v_mfma_f32_16x16x32_bf16 v[44:47], v[232:235], v[28:31], v[44:47]
  v_mfma_f32_16x16x32_bf16 v[52:55], v[236:239], v[28:31], v[52:55]
  s_cmp_lg_u32 s15, 3
  s_cbranch_scc1 SXW_183
  s_mov_b64 exec, 0xffff
  ds_write2_b32 v10, v56, v60 offset0:0 offset1:16
  s_mov_b64 exec, -1
SXW_183:
  v_mfma_f32_16x16x32_bf16 v[40:43], v[244:247], v[32:35], v[40:43]
  v_mfma_f32_16x16x32_bf16 v[48:51], v[248:251], v[32:35], v[48:51]
  v_mfma_f32_16x16x32_bf16 v[44:47], v[244:247], v[36:39], v[44:47]
  v_mfma_f32_16x16x32_bf16 v[52:55], v[248:251], v[36:39], v[52:55]
  ds_read_b128 v[28:31], v2 offset:0
  ds_read_b128 v[32:35], v2 offset:16
  ds_read_b128 v[36:39], v2 offset:32
  ds_read2_b32 v[24:25], v10 offset0:0 offset1:16
  s_waitcnt lgkmcnt(0)
SK_185:
  v_max_u32 v26, v24, v25
  v_cmp_eq_u32 vcc, -1, v26
  s_cbranch_vccnz SC_184
SD_186:
  v_fma_f32 v56, v24, v36, v56
  v_fma_f32 v57, v24, v37, v57
  v_fma_f32 v58, v24, v38, v58
  v_fma_f32 v59, v24, v39, v59
  v_fma_f32 v60, v25, v36, v60
  v_fma_f32 v61, v25, v37, v61
  v_fma_f32 v62, v25, v38, v62
  v_fma_f32 v63, v25, v39, v63
  v_cvt_pk_bf16_f32 v56, v56, v57
  v_cvt_pk_bf16_f32 v57, v58, v59
  v_cvt_pk_bf16_f32 v58, v60, v61
  v_cvt_pk_bf16_f32 v59, v62, v63
  v_pk_max_i16 v56, v56, 0
  v_pk_max_i16 v57, v57, 0
  v_pk_max_i16 v58, v58, 0
  v_pk_max_i16 v59, v59, 0
  s_nop 0
  v_permlane16_swap_b32 v56, v58
  v_permlane16_swap_b32 v57, v59
  s_add_u32 s12, s29, 0
  s_cmp_eq_u32 s28, 32
  s_cbranch_scc0 LC_187
  buffer_store_dwordx4 v[56:59], v7, s[40:43], s12 offen
LD_188:
  v_fma_f32 v40, v24, v28, v40
  v_fma_f32 v41, v24, v29, v41
  v_fma_f32 v42, v24, v30, v42
  v_fma_f32 v43, v24, v31, v43
  v_fma_f32 v44, v25, v28, v44
  v_fma_f32 v45, v25, v29, v45
  v_fma_f32 v46, v25, v30, v46
  v_fma_f32 v47, v25, v31, v47
  v_cvt_pk_bf16_f32 v40, v40, v41
  v_cvt_pk_bf16_f32 v41, v42, v43
  v_cvt_pk_bf16_f32 v42, v44, v45
  v_cvt_pk_bf16_f32 v43, v46, v47
  v_pk_max_i16 v40, v40, 0
  v_pk_max_i16 v41, v41, 0
  v_pk_max_i16 v42, v42, 0
  v_pk_max_i16 v43, v43, 0
  s_nop 0
  v_permlane16_swap_b32 v40, v42
  v_permlane16_swap_b32 v41, v43
  s_add_u32 s12, s26, 0
  s_cmp_eq_u32 s28, 32
  s_cbranch_scc0 LC_189
  buffer_store_dwordx4 v[40:43], v7, s[40:43], s12 offen
LD_190:
  v_fma_f32 v48, v24, v32, v48
  v_fma_f32 v49, v24, v33, v49
  v_fma_f32 v50, v24, v34, v50
  v_fma_f32 v51, v24, v35, v51
  v_fma_f32 v52, v25, v32, v52
  v_fma_f32 v53, v25, v33, v53
  v_fma_f32 v54, v25, v34, v54
  v_fma_f32 v55, v25, v35, v55
  v_cvt_pk_bf16_f32 v48, v48, v49
  v_cvt_pk_bf16_f32 v49, v50, v51
  v_cvt_pk_bf16_f32 v50, v52, v53
  v_cvt_pk_bf16_f32 v51, v54, v55
  v_pk_max_i16 v48, v48, 0
  v_pk_max_i16 v49, v49, 0
  v_pk_max_i16 v50, v50, 0
  v_pk_max_i16 v51, v51, 0
  s_nop 0
  v_permlane16_swap_b32 v48, v50
  v_permlane16_swap_b32 v49, v51
  s_add_u32 s12, s57, 0
  s_cmp_eq_u32 s28, 32
  s_cbranch_scc0 LC_191
  buffer_store_dwordx4 v[48:51], v7, s[40:43], s12 offen
LD_192:
  s_setprio 2
  v_add_u32 v11, s64, v7
  s_mov_b32 s60, 1
  ds_read_b32 v1, v3 offset:36
  s_waitcnt lgkmcnt(0)
  v_cmp_gt_u32 vcc, 4, v1
  s_cbranch_vccz XW_193
  s_waitcnt vmcnt(0)
  s_add_u32 s11, s18, 16384
  s_mov_b64 exec, 1
  s_cmp_eq_u32 s28, 32
  s_cbranch_scc0 LC_194
  buffer_store_dword v5, off, s[40:43], s11
LD_195:
  s_mov_b64 exec, -1
  s_mov_b32 s60, 0
  ds_read_b32 v1, v3 offset:36
  s_waitcnt lgkmcnt(0)
SK_197:
  v_cmp_gt_u32 vcc, 4, v1
  s_cbranch_vccnz SC_196
SD_198:
XW_193:
  ds_read_b128 v[24:27], v11 offset:32768
  ds_read_b128 v[28:31], v11 offset:33792
  ds_read_b128 v[32:35], v11 offset:34816
  ds_read_b128 v[36:39], v11 offset:35840
  s_waitcnt lgkmcnt(2)
  v_mfma_f32_16x16x32_bf16 v[40:43], v[64:67], v[24:27], 0
  v_mfma_f32_16x16x32_bf16 v[48:51], v[68:71], v[24:27], 0
  v_mfma_f32_16x16x32_bf16 v[56:59], v[72:75], v[24:27], 0
  ds_read_b128 v[24:27], v11 offset:36864
  v_mfma_f32_16x16x32_bf16 v[44:47], v[64:67], v[28:31], 0
  v_mfma_f32_16x16x32_bf16 v[52:55], v[68:71], v[28:31], 0
  v_mfma_f32_16x16x32_bf16 v[60:63], v[72:75], v[28:31], 0
  s_cmp_eq_u32 s60, 1
  s_cbranch_scc0 HF_199
  s_waitcnt vmcnt(0)
  s_add_u32 s11, s18, 16384
  s_mov_b64 exec, 1
  s_cmp_eq_u32 s28, 32
  s_cbranch_scc0 LC_200
  buffer_store_dword v5, off, s[40:43], s11
LD_201:
  s_mov_b64 exec, -1
HF_199:
  ds_read_b128 v[28:31], v11 offset:37888
  s_waitcnt lgkmcnt(2)
  v_mfma_f32_16x16x32_bf16 v[40:43], v[76:79], v[32:35], v[40:43]
  v_mfma_f32_16x16x32_bf16 v[48:51], v[80:83], v[32:35], v[48:51]
  v_mfma_f32_16x16x32_bf16 v[56:59], v[84:87], v[32:35], v[56:59]
  ds_read_b128 v[32:35], v11 offset:38912
  v_mfma_f32_16x16x32_bf16 v[44:47], v[76:79], v[36:39], v[44:47]
  v_mfma_f32_16x16x32_bf16 v[52:55], v[80:83], v[36:39], v[52:55]
  v_mfma_f32_16x16x32_bf16 v[60:63], v[84:87], v[36:39], v[60:63]
  ds_read_b128 v[36:39], v11 offset:39936
  s_waitcnt lgkmcnt(2)
  v_mfma_f32_16x16x32_bf16 v[40:43], v[88:91], v[24:27], v[40:43]
  v_mfma_f32_16x16x32_bf16 v[48:51], v[92:95], v[24:27], v[48:51]
  v_mfma_f32_16x16x32_bf16 v[56:59], v[96:99], v[24:27], v[56:59]
  v_add_u32 v11, s65, v7
  ds_read_b128 v[24:27], v11 offset:32768
  v_mfma_f32_16x16x32_bf16 v[44:47], v[88:91], v[28:31], v[44:47]
  v_mfma_f32_16x16x32_bf16 v[52:55], v[92:95], v[28:31], v[52:55]
  v_mfma_f32_16x16x32_bf16 v[60:63], v[96:99], v[28:31], v[60:63]
  ds_read_b128 v[28:31], v11 offset:33792
  s_waitcnt lgkmcnt(2)
  v_mfma_f32_16x16x32_bf16 v[40:43], v[100:103], v[32:35], v[40:43]
  v_mfma_f32_16x16x32_bf16 v[48:51], v[104:107], v[32:35], v[48:51]
  v_mfma_f32_16x16x32_bf16 v[56:59], v[108:111], v[32:35], v[56:59]
  ds_read_b128 v[32:35], v11 offset:34816
  v_mfma_f32_16x16x32_bf16 v[44:47], v[100:103], v[36:39], v[44:47]
  v_mfma_f32_16x16x32_bf16 v[52:55], v[104:107], v[36:39], v[52:55]
  v_mfma_f32_16x16x32_bf16 v[60:63], v[108:111], v[36:39], v[60:63]
  ds_read_b128 v[36:39], v11 offset:35840
  s_waitcnt lgkmcnt(2)
  v_mfma_f32_16x16x32_bf16 v[40:43], v[112:115], v[24:27], v[40:43]
  v_mfma_f32_16x16x32_bf16 v[48:51], v[116:119], v[24:27], v[48:51]
  v_mfma_f32_16x16x32_bf16 v[56:59], v[120:123], v[24:27], v[56:59]
  ds_read_b128 v[24:27], v11 offset:36864
  v_mfma_f32_16x16x32_bf16 v[44:47], v[112:115], v[28:31], v[44:47]
  v_mfma_f32_16x16x32_bf16 v[52:55], v[116:119], v[28:31], v[52:55]
  v_mfma_f32_16x16x32_bf16 v[60:63], v[120:123], v[28:31], v[60:63]
  ds_read_b128 v[28:31], v11 offset:37888
  s_waitcnt lgkmcnt(2)
  v_mfma_f32_16x16x32_bf16 v[40:43], v[124:127], v[32:35], v[40:43]
  v_mfma_f32_16x16x32_bf16 v[48:51], v[128:131], v[32:35], v[48:51]
  v_mfma_f32_16x16x32_bf16 v[56:59], v[132:135], v[32:35], v[56:59]
  ds_read_b128 v[32:35], v11 offset:38912
  v_mfma_f32_16x16x32_bf16 v[44:47], v[124:127], v[36:39], v[44:47]
  v_mfma_f32_16x16x32_bf16 v[52:55], v[128:131], v[36:39], v[52:55]
  v_mfma_f32_16x16x32_bf16 v[60:63], v[132:135], v[36:39], v[60:63]
  ds_read_b128 v[36:39], v11 offset:39936
  s_waitcnt lgkmcnt(2)
  v_mfma_f32_16x16x32_bf16 v[40:43], v[136:139], v[24:27], v[40:43]
  v_mfma_f32_16x16x32_bf16 v[48:51], v[140:143], v[24:27], v[48:51]
  v_mfma_f32_16x16x32_bf16 v[56:59], v[144:147], v[24:27], v[56:59]
  v_add_u32 v11, s66, v7
  ds_read_b128 v[24:27], v11 offset:32768
  v_mfma_f32_16x16x32_bf16 v[44:47], v[136:139], v[28:31], v[44:47]
  v_mfma_f32_16x16x32_bf16 v[52:55], v[140:143], v[28:31], v[52:55]
  v_mfma_f32_16x16x32_bf16 v[60:63], v[144:147], v[28:31], v[60:63]
  ds_read_b128 v[28:31], v11 offset:33792
  s_waitcnt lgkmcnt(2)
  v_mfma_f32_16x16x32_bf16 v[40:43], v[148:151], v[32:35], v[40:43]
  v_mfma_f32_16x16x32_bf16 v[48:51], v[152:155], v[32:35], v[48:51]
  v_mfma_f32_16x16x32_bf16 v[56:59], v[156:159], v[32:35], v[56:59]
  ds_read_b128 v[32:35], v11 offset:34816
  v_mfma_f32_16x16x32_bf16 v[44:47], v[148:151], v[36:39], v[44:47]
  v_mfma_f32_16x16x32_bf16 v[52:55], v[152:155], v[36:39], v[52:55]
  v_mfma_f32_16x16x32_bf16 v[60:63], v[156:159], v[36:39], v[60:63]
  ds_read_b128 v[36:39], v11 offset:35840
  s_waitcnt lgkmcnt(2)
  v_mfma_f32_16x16x32_bf16 v[40:43], v[160:163], v[24:27], v[40:43]
  v_mfma_f32_16x16x32_bf16 v[48:51], v[164:167], v[24:27], v[48:51]
  v_mfma_f32_16x16x32_bf16 v[56:59], v[168:171], v[24:27], v[56:59]
  ds_read_b128 v[24:27], v11 offset:36864
  v_mfma_f32_16x16x32_bf16 v[44:47], v[160:163], v[28:31], v[44:47]
  v_mfma_f32_16x16x32_bf16 v[52:55], v[164:167], v[28:31], v[52:55]
  v_mfma_f32_16x16x32_bf16 v[60:63], v[168:171], v[28:31], v[60:63]
  ds_read_b128 v[28:31], v11 offset:37888
  s_waitcnt lgkmcnt(2)
  v_mfma_f32_16x16x32_bf16 v[40:43], v[172:175], v[32:35], v[40:43]
  v_mfma_f32_16x16x32_bf16 v[48:51], v[176:179], v[32:35], v[48:51]
  v_mfma_f32_16x16x32_bf16 v[56:59], v[180:183], v[32:35], v[56:59]
  ds_read_b128 v[32:35], v11 offset:38912
  v_mfma_f32_16x16x32_bf16 v[44:47], v[172:175], v[36:39], v[44:47]
  v_mfma_f32_16x16x32_bf16 v[52:55], v[176:179], v[36:39], v[52:55]
  v_mfma_f32_16x16x32_bf16 v[60:63], v[180:183], v[36:39], v[60:63]
  ds_read_b128 v[36:39], v11 offset:39936
  s_waitcnt lgkmcnt(2)
  v_mfma_f32_16x16x32_bf16 v[40:43], v[184:187], v[24:27], v[40:43]
  v_mfma_f32_16x16x32_bf16 v[48:51], v[188:191], v[24:27], v[48:51]
  v_mfma_f32_16x16x32_bf16 v[56:59], v[192:195], v[24:27], v[56:59]
  v_add_u32 v11, s67, v7
  ds_read_b128 v[24:27], v11 offset:32768
  v_mfma_f32_16x16x32_bf16 v[44:47], v[184:187], v[28:31], v[44:47]
  v_mfma_f32_16x16x32_bf16 v[52:55], v[188:191], v[28:31], v[52:55]
  v_mfma_f32_16x16x32_bf16 v[60:63], v[192:195], v[28:31], v[60:63]
  ds_read_b128 v[28:31], v11 offset:33792
  s_waitcnt lgkmcnt(2)
  v_mfma_f32_16x16x32_bf16 v[40:43], v[196:199], v[32:35], v[40:43]
  v_mfma_f32_16x16x32_bf16 v[48:51], v[200:203], v[32:35], v[48:51]
  v_mfma_f32_16x16x32_bf16 v[56:59], v[204:207], v[32:35], v[56:59]
  ds_read_b128 v[32:35], v11 offset:34816
  v_mfma_f32_16x16x32_bf16 v[44:47], v[196:199], v[36:39], v[44:47]
  v_mfma_f32_16x16x32_bf16 v[52:55], v[200:203], v[36:39], v[52:55]
  v_mfma_f32_16x16x32_bf16 v[60:63], v[204:207], v[36:39], v[60:63]
  ds_read_b128 v[36:39], v11 offset:35840
  s_waitcnt lgkmcnt(2)
  v_mfma_f32_16x16x32_bf16 v[40:43], v[208:211], v[24:27], v[40:43]
  v_mfma_f32_16x16x32_bf16 v[48:51], v[212:215], v[24:27], v[48:51]
  v_mfma_f32_16x16x32_bf16 v[56:59], v[216:219], v[24:27], v[56:59]
  ds_read_b128 v[24:27], v11 offset:36864
  v_mfma_f32_16x16x32_bf16 v[44:47], v[208:211], v[28:31], v[44:47]
  v_mfma_f32_16x16x32_bf16 v[52:55], v[212:215], v[28:31], v[52:55]
  v_mfma_f32_16x16x32_bf16 v[60:63], v[216:219], v[28:31], v[60:63]
  ds_read_b128 v[28:31], v11 offset:37888
  s_waitcnt lgkmcnt(2)
  v_mfma_f32_16x16x32_bf16 v[40:43], v[220:223], v[32:35], v[40:43]
  v_mfma_f32_16x16x32_bf16 v[48:51], v[224:227], v[32:35], v[48:51]
  v_mfma_f32_16x16x32_bf16 v[56:59], v[228:231], v[32:35], v[56:59]
  ds_read_b128 v[32:35], v11 offset:38912
  v_mfma_f32_16x16x32_bf16 v[44:47], v[220:223], v[36:39], v[44:47]
  v_mfma_f32_16x16x32_bf16 v[52:55], v[224:227], v[36:39], v[52:55]
  v_mfma_f32_16x16x32_bf16 v[60:63], v[228:231], v[36:39], v[60:63]
  ds_read_b128 v[36:39], v11 offset:39936
  s_waitcnt lgkmcnt(3)
  v_mfma_f32_16x16x32_bf16 v[56:59], v[240:243], v[24:27], v[56:59]
  s_waitcnt lgkmcnt(2)
  v_mfma_f32_16x16x32_bf16 v[60:63], v[240:243], v[28:31], v[60:63]
  s_waitcnt lgkmcnt(1)
  v_mfma_f32_16x16x32_bf16 v[56:59], v[252:255], v[32:35], v[56:59]
  s_waitcnt lgkmcnt(0)
  v_mfma_f32_16x16x32_bf16 v[60:63], v[252:255], v[36:39], v[60:63]
  s_mov_b64 exec, 1
  ds_add_u32 v3, v4 offset:52
  s_mov_b64 exec, -1
  v_mfma_f32_16x16x32_bf16 v[40:43], v[232:235], v[24:27], v[40:43]
  v_mfma_f32_16x16x32_bf16 v[48:51], v[236:239], v[24:27], v[48:51]
  v_mfma_f32_16x16x32_bf16 v[44:47], v[232:235], v[28:31], v[44:47]
  v_mfma_f32_16x16x32_bf16 v[52:55], v[236:239], v[28:31], v[52:55]
  s_cmp_lg_u32 s15, 3
  s_cbranch_scc1 SXW_202
  s_mov_b64 exec, 0xffff
  ds_write2_b32 v10, v56, v60 offset0:32 offset1:48
  s_mov_b64 exec, -1
SXW_202:
  v_mfma_f32_16x16x32_bf16 v[40:43], v[244:247], v[32:35], v[40:43]
  v_mfma_f32_16x16x32_bf16 v[48:51], v[248:251], v[32:35], v[48:51]
  v_mfma_f32_16x16x32_bf16 v[44:47], v[244:247], v[36:39], v[44:47]
  v_mfma_f32_16x16x32_bf16 v[52:55], v[248:251], v[36:39], v[52:55]
  ds_read_b128 v[28:31], v2 offset:0
  ds_read_b128 v[32:35], v2 offset:16
  ds_read_b128 v[36:39], v2 offset:32
  ds_read2_b32 v[24:25], v10 offset0:32 offset1:48
  s_waitcnt lgkmcnt(0)
SK_204:
  v_max_u32 v26, v24, v25
  v_cmp_eq_u32 vcc, -1, v26
  s_cbranch_vccnz SC_203
SD_205:
  v_fma_f32 v56, v24, v36, v56
  v_fma_f32 v57, v24, v37, v57
  v_fma_f32 v58, v24, v38, v58
  v_fma_f32 v59, v24, v39, v59
  v_fma_f32 v60, v25, v36, v60
  v_fma_f32 v61, v25, v37, v61
  v_fma_f32 v62, v25, v38, v62
  v_fma_f32 v63, v25, v39, v63
  v_cvt_pk_bf16_f32 v56, v56, v57
  v_cvt_pk_bf16_f32 v57, v58, v59
  v_cvt_pk_bf16_f32 v58, v60, v61
  v_cvt_pk_bf16_f32 v59, v62, v63
  v_pk_max_i16 v56, v56, 0
  v_pk_max_i16 v57, v57, 0
  v_pk_max_i16 v58, v58, 0
  v_pk_max_i16 v59, v59, 0
  s_nop 0
  v_permlane16_swap_b32 v56, v58
  v_permlane16_swap_b32 v57, v59
  s_add_u32 s12, s29, 2883584
  s_cmp_eq_u32 s28, 32
  s_cbranch_scc0 LC_206
  buffer_store_dwordx4 v[56:59], v7, s[40:43], s12 offen
LD_207:
  v_fma_f32 v40, v24, v28, v40
  v_fma_f32 v41, v24, v29, v41
  v_fma_f32 v42, v24, v30, v42
  v_fma_f32 v43, v24, v31, v43
  v_fma_f32 v44, v25, v28, v44
  v_fma_f32 v45, v25, v29, v45
  v_fma_f32 v46, v25, v30, v46
  v_fma_f32 v47, v25, v31, v47
  v_cvt_pk_bf16_f32 v40, v40, v41
  v_cvt_pk_bf16_f32 v41, v42, v43
  v_cvt_pk_bf16_f32 v42, v44, v45
  v_cvt_pk_bf16_f32 v43, v46, v47
  v_pk_max_i16 v40, v40, 0
  v_pk_max_i16 v41, v41, 0
  v_pk_max_i16 v42, v42, 0
  v_pk_max_i16 v43, v43, 0
  s_nop 0
  v_permlane16_swap_b32 v40, v42
  v_permlane16_swap_b32 v41, v43
  s_add_u32 s12, s26, 2883584
  s_cmp_eq_u32 s28, 32
  s_cbranch_scc0 LC_208
  buffer_store_dwordx4 v[40:43], v7, s[40:43], s12 offen
LD_209:
  v_fma_f32 v48, v24, v32, v48
  v_fma_f32 v49, v24, v33, v49
  v_fma_f32 v50, v24, v34, v50
  v_fma_f32 v51, v24, v35, v51
  v_fma_f32 v52, v25, v32, v52
  v_fma_f32 v53, v25, v33, v53
  v_fma_f32 v54, v25, v34, v54
  v_fma_f32 v55, v25, v35, v55
  v_cvt_pk_bf16_f32 v48, v48, v49
  v_cvt_pk_bf16_f32 v49, v50, v51
  v_cvt_pk_bf16_f32 v50, v52, v53
  v_cvt_pk_bf16_f32 v51, v54, v55
  v_pk_max_i16 v48, v48, 0
  v_pk_max_i16 v49, v49, 0
  v_pk_max_i16 v50, v50, 0
  v_pk_max_i16 v51, v51, 0
  s_nop 0
  v_permlane16_swap_b32 v48, v50
  v_permlane16_swap_b32 v49, v51
  s_add_u32 s12, s57, 2883584
  s_cmp_eq_u32 s28, 32
  s_cbranch_scc0 LC_210
  buffer_store_dwordx4 v[48:51], v7, s[40:43], s12 offen
LD_211:
  s_add_u32 s13, s23, 262144
  buffer_load_dwordx4 v[24:27], v7, s[40:43], s13 offen sc1
  s_waitcnt vmcnt(0)
  s_add_u32 s11, s18, 32768
  s_mov_b64 exec, 1
  s_cmp_eq_u32 s28, 32
  s_cbranch_scc0 LC_212
  buffer_store_dword v5, off, s[40:43], s11
LD_213:
  s_mov_b64 exec, -1
SK_215:
  v_xor_b32 v25, v5, v25
  v_xor_b32 v27, v5, v27
  v_or_b32 v25, v25, v27
  v_cmp_ne_u32 vcc, 0, v25
  s_cbranch_vccnz SC_214
SD_216:
  v_add_f32 v24, v24, v24 row_ror:8
  v_add_f32 v26, v26, v26 row_ror:8
  s_nop 1
  v_permlane16_swap_b32 v24, v26
  v_add_f32 v24, v24, v26
  v_mov_b32 v27, v24
  s_nop 1
  v_permlane32_swap_b32 v24, v27
  v_add_f32 v24, v24, v27
  v_mov_b32 v26, v24
  s_nop 1
  v_permlane16_swap_b32 v24, v26
  v_mul_f32 v24, s61, v24
  v_mul_f32 v26, s61, v26
  v_fma_f32 v26, -v24, v24, v26
  v_max_f32 v26, 0, v26
  v_add_f32 v26, s62, v26
  v_rsq_f32 v6, v26
  v_and_b32 v1, 7, v0
  v_lshlrev_b32 v1, 14, v1
  s_add_u32 s11, s19, 16384
  v_add_u32 v1, s11, v1
  v_and_b32 v9, 3, v0
  v_lshlrev_b32 v9, 17, v9
  v_add_u32 v9, s22, v9
  v_cmp_le_u32 vcc, 8, v0
  s_nop 1
  v_cndmask_b32 v1, v1, v9, vcc
  buffer_load_dword v9, v1, s[40:43], 0 offen sc1
  s_setprio 3
  s_setprio 3
  v_xor_b32 v25, 128, v20
  ds_read_b32 v24, v3 offset:64
  s_waitcnt lgkmcnt(0)
SK_218:
  v_cmp_gt_u32 vcc, 4, v24
  s_cbranch_vccnz SC_217
SD_219:
  ds_read_b128 v[32:35], v20 offset:0
  ds_read_b128 v[36:39], v25 offset:0
  ds_read_b128 v[40:43], v20 offset:8192
  ds_read_b128 v[44:47], v25 offset:8192
  ds_read_b128 v[48:51], v20 offset:16384
  ds_read_b128 v[52:55], v25 offset:16384
  ds_read_b128 v[56:59], v20 offset:24576
  ds_read_b128 v[60:63], v25 offset:24576
  s_mov_b64 exec, 1
  ds_add_u32 v3, v4 offset:80
  s_mov_b64 exec, -1
  s_waitcnt lgkmcnt(5)
  v_add_f32 v32, v32, v40
  v_add_f32 v33, v33, v41
  v_add_f32 v34, v34, v42
  v_add_f32 v35, v35, v43
  v_add_f32 v36, v36, v44
  v_add_f32 v37, v37, v45
  v_add_f32 v38, v38, v46
  v_add_f32 v39, v39, v47
  v_lshlrev_b32 v40, 16, v12
  v_and_b32 v41, 0xffff0000, v12
  v_lshlrev_b32 v42, 16, v13
  v_and_b32 v43, 0xffff0000, v13
  v_lshlrev_b32 v44, 16, v14
  v_and_b32 v45, 0xffff0000, v14
  v_lshlrev_b32 v46, 16, v15
  v_and_b32 v47, 0xffff0000, v15
  v_fma_f32 v40, v32, v6, v40
  v_fma_f32 v41, v33, v6, v41
  v_fma_f32 v42, v34, v6, v42
  v_fma_f32 v43, v35, v6, v43
  v_fma_f32 v44, v36, v6, v44
  v_fma_f32 v45, v37, v6, v45
  v_fma_f32 v46, v38, v6, v46
  v_fma_f32 v47, v39, v6, v47
  s_waitcnt lgkmcnt(1)
  v_add_f32 v48, v48, v56
  v_add_f32 v49, v49, v57
  v_add_f32 v50, v50, v58
  v_add_f32 v51, v51, v59
  v_add_f32 v52, v52, v60
  v_add_f32 v53, v53, v61
  v_add_f32 v54, v54, v62
  v_add_f32 v55, v55, v63
  v_fma_f32 v40, v48, v6, v40
  v_fma_f32 v41, v49, v6, v41
  v_fma_f32 v42, v50, v6, v42
  v_fma_f32 v43, v51, v6, v43
  v_fma_f32 v44, v52, v6, v44
  v_fma_f32 v45, v53, v6, v45
  v_fma_f32 v46, v54, v6, v46
  v_fma_f32 v47, v55, v6, v47
  v_add_f32 v24, v40, v41
  v_mul_f32 v26, v40, v40
  v_add_f32 v25, v42, v43
  v_mul_f32 v27, v41, v41
  v_fmac_f32 v26, v42, v42
  v_fmac_f32 v27, v43, v43
  v_fmac_f32 v26, v44, v44
  v_add_f32 v24, v24, v44
  v_fmac_f32 v27, v45, v45
  v_add_f32 v25, v25, v45
  v_fmac_f32 v26, v46, v46
  v_add_f32 v24, v24, v46
  v_fmac_f32 v27, v47, v47
  v_add_f32 v25, v25, v47
  v_add_f32 v24, v24, v25
  v_add_f32 v26, v26, v27
  s_add_u32 s11, s22, 0
  v_xor_b32 v25, 2, v5
  v_add_f32 v24, v24, v24 row_ror:8
  v_add_f32 v26, v26, v26 row_ror:8
  s_nop 1
  v_permlane16_swap_b32 v24, v26
  v_add_f32 v24, v24, v26
  v_mov_b32 v27, v24
  s_nop 1
  v_permlane32_swap_b32 v24, v27
  v_add_f32 v24, v24, v27
  s_mov_b64 exec, 0xff00ff
  s_cmp_eq_u32 s28, 32
  s_cbranch_scc0 LC_220
  buffer_store_dwordx2 v[24:25], v21, s[40:43], s11 offen
LD_221:
  s_mov_b64 exec, -1
  v_cvt_pk_bf16_f32 v12, v40, v41
  v_cvt_pk_bf16_f32 v13, v42, v43
  v_cvt_pk_bf16_f32 v14, v44, v45
  v_cvt_pk_bf16_f32 v15, v46, v47
  s_add_u32 s13, s23, 0
  buffer_load_dwordx4 v[24:27], v7, s[40:43], s13 offen sc1
  v_lshlrev_b32 v32, 16, v12
  v_and_b32 v33, 0xffff0000, v12
  v_lshlrev_b32 v34, 16, v13
  v_and_b32 v35, 0xffff0000, v13
  v_lshlrev_b32 v36, 16, v14
  v_and_b32 v37, 0xffff0000, v14
  v_lshlrev_b32 v38, 16, v15
  v_and_b32 v39, 0xffff0000, v15
  v_lshlrev_b32 v40, 16, v16
  v_and_b32 v41, 0xffff0000, v16
  v_lshlrev_b32 v42, 16, v17
  v_and_b32 v43, 0xffff0000, v17
  v_lshlrev_b32 v44, 16, v18
  v_and_b32 v45, 0xffff0000, v18
  v_lshlrev_b32 v46, 16, v19
  v_and_b32 v47, 0xffff0000, v19
  s_waitcnt vmcnt(0)
SK_223:
  v_xor_b32 v25, v5, v25
  v_xor_b32 v27, v5, v27
  v_xor_b32 v25, 2, v25
  v_xor_b32 v27, 2, v27
  v_or_b32 v25, v25, v27
  v_cmp_ne_u32 vcc, 0, v25
  s_cbranch_vccnz SC_222
SD_224:
  v_add_f32 v24, v24, v24 row_ror:8
  v_add_f32 v26, v26, v26 row_ror:8
  s_nop 1
  v_permlane16_swap_b32 v24, v26
  v_add_f32 v24, v24, v26
  v_mov_b32 v27, v24
  s_nop 1
  v_permlane32_swap_b32 v24, v27
  v_add_f32 v24, v24, v27
  v_mov_b32 v26, v24
  s_nop 1
  v_permlane16_swap_b32 v24, v26
  v_mul_f32 v24, s61, v24
  v_mul_f32 v26, s61, v26
  v_fma_f32 v26, -v24, v24, v26
  v_max_f32 v26, 0, v26
  v_add_f32 v26, s62, v26
  v_rsq_f32 v26, v26
  s_nop 0
  v_mul_f32 v24, -v24, v26
  v_fma_f32 v48, v32, v26, v24
  v_fma_f32 v49, v33, v26, v24
  v_fma_f32 v50, v34, v26, v24
  v_fma_f32 v51, v35, v26, v24
  v_fma_f32 v52, v36, v26, v24
  v_fma_f32 v53, v37, v26, v24
  v_fma_f32 v54, v38, v26, v24
  v_fma_f32 v55, v39, v26, v24
  v_fma_f32 v32, v48, v40, v32
  v_fma_f32 v33, v49, v41, v33
  v_fma_f32 v34, v50, v42, v34
  v_fma_f32 v35, v51, v43, v35
  v_fma_f32 v36, v52, v44, v36
  v_fma_f32 v37, v53, v45, v37
  v_fma_f32 v38, v54, v46, v38
  v_fma_f32 v39, v55, v47, v39
  v_cvt_pk_bf16_f32 v12, v32, v33
  v_cvt_pk_bf16_f32 v13, v34, v35
  v_cvt_pk_bf16_f32 v14, v36, v37
  v_cvt_pk_bf16_f32 v15, v38, v39
  s_add_u32 s11, s24, 0
  s_cmp_eq_u32 s28, 32
  s_cbranch_scc0 LC_225
  buffer_store_dwordx4 v[12:15], v22, s[40:43], s11 offen
LD_226:
  v_add_f32 v24, v32, v33
  v_mul_f32 v26, v32, v32
  v_add_f32 v25, v34, v35
  v_mul_f32 v27, v33, v33
  v_fmac_f32 v26, v34, v34
  v_fmac_f32 v27, v35, v35
  v_fmac_f32 v26, v36, v36
  v_add_f32 v24, v24, v36
  v_fmac_f32 v27, v37, v37
  v_add_f32 v25, v25, v37
  v_fmac_f32 v26, v38, v38
  v_add_f32 v24, v24, v38
  v_fmac_f32 v27, v39, v39
  v_add_f32 v25, v25, v39
  v_add_f32 v24, v24, v25
  v_add_f32 v26, v26, v27
  s_add_u32 s11, s22, 262144
  v_xor_b32 v25, 2, v5
  v_add_f32 v24, v24, v24 row_ror:8
  v_add_f32 v26, v26, v26 row_ror:8
  s_nop 1
  v_permlane16_swap_b32 v24, v26
  v_add_f32 v24, v24, v26
  v_mov_b32 v27, v24
  s_nop 1
  v_permlane32_swap_b32 v24, v27
  v_add_f32 v24, v24, v27
  s_mov_b64 exec, 0xff00ff
  s_cmp_eq_u32 s28, 32
  s_cbranch_scc0 LC_227
  buffer_store_dwordx2 v[24:25], v21, s[40:43], s11 offen
LD_228:
  s_mov_b64 exec, -1
  s_waitcnt vmcnt(1)
  s_add_u32 s11, s18, 114688
  s_mov_b64 exec, 1
  s_cmp_eq_u32 s28, 32
  s_cbranch_scc0 LC_229
  buffer_store_dword v5, off, s[40:43], s11
LD_230:
  s_mov_b64 exec, -1
  s_setprio 2
  s_add_u32 s14, s19, 114688
  s_lshl_b32 s13, s15, 13
  s_add_u32 m0, s13, 0
  s_add_u32 s12, s21, s13
  s_add_u32 s12, s12, 0
  ds_read_b32 v30, v3 offset:80
  s_waitcnt lgkmcnt(0)
SK_232:
  v_cmp_gt_u32 vcc, 4, v30
  s_cbranch_vccnz SC_231
SD_233:
  buffer_load_dword v28, v8, s[40:43], s14 offen sc1
  s_waitcnt vmcnt(0)
SK_235:
  v_cmp_ne_u32 vcc, s9, v28
  s_cbranch_vccnz SC_234
SD_236:
  buffer_load_dwordx4 v7, s[40:43], s12 offen offset:0 sc1 lds
  buffer_load_dwordx4 v7, s[40:43], s12 offen offset:1024 sc1 lds
  buffer_load_dwordx4 v7, s[40:43], s12 offen offset:2048 sc1 lds
  buffer_load_dwordx4 v7, s[40:43], s12 offen offset:3072 sc1 lds
  s_add_u32 s12, s12, 4096
  s_add_u32 m0, m0, 4096
  s_nop 0
  buffer_load_dwordx4 v7, s[40:43], s12 offen offset:0 sc1 lds
  buffer_load_dwordx4 v7, s[40:43], s12 offen offset:1024 sc1 lds
  buffer_load_dwordx4 v7, s[40:43], s12 offen offset:2048 sc1 lds
  buffer_load_dwordx4 v7, s[40:43], s12 offen offset:3072 sc1 lds
  v_add_u32 v11, s64, v7
  s_waitcnt vmcnt(0)
  s_mov_b64 exec, 1
  ds_add_u32 v3, v4 offset:40
  s_mov_b64 exec, -1
  ds_read_b32 v1, v3 offset:40
  s_waitcnt lgkmcnt(0)
SK_238:
  v_cmp_gt_u32 vcc, 4, v1
  s_cbranch_vccnz SC_237
SD_239:
  ds_read_b128 v[24:27], v11 offset:0
  ds_read_b128 v[28:31], v11 offset:1024
  ds_read_b128 v[32:35], v11 offset:2048
  ds_read_b128 v[36:39], v11 offset:3072
  s_waitcnt lgkmcnt(2)
  v_mfma_f32_16x16x32_bf16 v[40:43], v[64:67], v[24:27], 0
  v_mfma_f32_16x16x32_bf16 v[48:51], v[68:71], v[24:27], 0
  v_mfma_f32_16x16x32_bf16 v[56:59], v[72:75], v[24:27], 0
  ds_read_b128 v[24:27], v11 offset:4096
  v_mfma_f32_16x16x32_bf16 v[44:47], v[64:67], v[28:31], 0
  v_mfma_f32_16x16x32_bf16 v[52:55], v[68:71], v[28:31], 0
  v_mfma_f32_16x16x32_bf16 v[60:63], v[72:75], v[28:31], 0
  ds_read_b128 v[28:31], v11 offset:5120
  s_waitcnt lgkmcnt(2)
  v_mfma_f32_16x16x32_bf16 v[40:43], v[76:79], v[32:35], v[40:43]
  v_mfma_f32_16x16x32_bf16 v[48:51], v[80:83], v[32:35], v[48:51]
  v_mfma_f32_16x16x32_bf16 v[56:59], v[84:87], v[32:35], v[56:59]
  ds_read_b128 v[32:35], v11 offset:6144
  v_mfma_f32_16x16x32_bf16 v[44:47], v[76:79], v[36:39], v[44:47]
  v_mfma_f32_16x16x32_bf16 v[52:55], v[80:83], v[36:39], v[52:55]
  v_mfma_f32_16x16x32_bf16 v[60:63], v[84:87], v[36:39], v[60:63]
  ds_read_b128 v[36:39], v11 offset:7168
  s_waitcnt lgkmcnt(2)
  v_mfma_f32_16x16x32_bf16 v[40:43], v[88:91], v[24:27], v[40:43]
  v_mfma_f32_16x16x32_bf16 v[48:51], v[92:95], v[24:27], v[48:51]
  v_mfma_f32_16x16x32_bf16 v[56:59], v[96:99], v[24:27], v[56:59]
  v_add_u32 v11, s65, v7
  ds_read_b128 v[24:27], v11 offset:0
  v_mfma_f32_16x16x32_bf16 v[44:47], v[88:91], v[28:31], v[44:47]
  v_mfma_f32_16x16x32_bf16 v[52:55], v[92:95], v[28:31], v[52:55]
  v_mfma_f32_16x16x32_bf16 v[60:63], v[96:99], v[28:31], v[60:63]
  ds_read_b128 v[28:31], v11 offset:1024
  s_waitcnt lgkmcnt(2)
  v_mfma_f32_16x16x32_bf16 v[40:43], v[100:103], v[32:35], v[40:43]
  v_mfma_f32_16x16x32_bf16 v[48:51], v[104:107], v[32:35], v[48:51]
  v_mfma_f32_16x16x32_bf16 v[56:59], v[108:111], v[32:35], v[56:59]
  ds_read_b128 v[32:35], v11 offset:2048
  v_mfma_f32_16x16x32_bf16 v[44:47], v[100:103], v[36:39], v[44:47]
  v_mfma_f32_16x16x32_bf16 v[52:55], v[104:107], v[36:39], v[52:55]
  v_mfma_f32_16x16x32_bf16 v[60:63], v[108:111], v[36:39], v[60:63]
  ds_read_b128 v[36:39], v11 offset:3072
  s_waitcnt lgkmcnt(2)
  v_mfma_f32_16x16x32_bf16 v[40:43], v[112:115], v[24:27], v[40:43]
  v_mfma_f32_16x16x32_bf16 v[48:51], v[116:119], v[24:27], v[48:51]
  v_mfma_f32_16x16x32_bf16 v[56:59], v[120:123], v[24:27], v[56:59]
  ds_read_b128 v[24:27], v11 offset:4096
  v_mfma_f32_16x16x32_bf16 v[44:47], v[112:115], v[28:31], v[44:47]
  v_mfma_f32_16x16x32_bf16 v[52:55], v[116:119], v[28:31], v[52:55]
  v_mfma_f32_16x16x32_bf16 v[60:63], v[120:123], v[28:31], v[60:63]
  ds_read_b128 v[28:31], v11 offset:5120
  s_waitcnt lgkmcnt(2)
  v_mfma_f32_16x16x32_bf16 v[40:43], v[124:127], v[32:35], v[40:43]
  v_mfma_f32_16x16x32_bf16 v[48:51], v[128:131], v[32:35], v[48:51]
  v_mfma_f32_16x16x32_bf16 v[56:59], v[132:135], v[32:35], v[56:59]
  ds_read_b128 v[32:35], v11 offset:6144
  v_mfma_f32_16x16x32_bf16 v[44:47], v[124:127], v[36:39], v[44:47]
  v_mfma_f32_16x16x32_bf16 v[52:55], v[128:131], v[36:39], v[52:55]
  v_mfma_f32_16x16x32_bf16 v[60:63], v[132:135], v[36:39], v[60:63]
  ds_read_b128 v[36:39], v11 offset:7168
  s_waitcnt lgkmcnt(2)
  v_mfma_f32_16x16x32_bf16 v[40:43], v[136:139], v[24:27], v[40:43]
  v_mfma_f32_16x16x32_bf16 v[48:51], v[140:143], v[24:27], v[48:51]
  v_mfma_f32_16x16x32_bf16 v[56:59], v[144:147], v[24:27], v[56:59]
  v_add_u32 v11, s66, v7
  ds_read_b128 v[24:27], v11 offset:0
  v_mfma_f32_16x16x32_bf16 v[44:47], v[136:139], v[28:31], v[44:47]
  v_mfma_f32_16x16x32_bf16 v[52:55], v[140:143], v[28:31], v[52:55]
  v_mfma_f32_16x16x32_bf16 v[60:63], v[144:147], v[28:31], v[60:63]
  ds_read_b128 v[28:31], v11 offset:1024
  s_waitcnt lgkmcnt(2)
  v_mfma_f32_16x16x32_bf16 v[40:43], v[148:151], v[32:35], v[40:43]
  v_mfma_f32_16x16x32_bf16 v[48:51], v[152:155], v[32:35], v[48:51]
  v_mfma_f32_16x16x32_bf16 v[56:59], v[156:159], v[32:35], v[56:59]
  ds_read_b128 v[32:35], v11 offset:2048
  v_mfma_f32_16x16x32_bf16 v[44:47], v[148:151], v[36:39], v[44:47]
  v_mfma_f32_16x16x32_bf16 v[52:55], v[152:155], v[36:39], v[52:55]
  v_mfma_f32_16x16x32_bf16 v[60:63], v[156:159], v[36:39], v[60:63]
  ds_read_b128 v[36:39], v11 offset:3072
  s_waitcnt lgkmcnt(2)
  v_mfma_f32_16x16x32_bf16 v[40:43], v[160:163], v[24:27], v[40:43]
  v_mfma_f32_16x16x32_bf16 v[48:51], v[164:167], v[24:27], v[48:51]
  v_mfma_f32_16x16x32_bf16 v[56:59], v[168:171], v[24:27], v[56:59]
  ds_read_b128 v[24:27], v11 offset:4096
  v_mfma_f32_16x16x32_bf16 v[44:47], v[160:163], v[28:31], v[44:47]
  v_mfma_f32_16x16x32_bf16 v[52:55], v[164:167], v[28:31], v[52:55]
  v_mfma_f32_16x16x32_bf16 v[60:63], v[168:171], v[28:31], v[60:63]
  ds_read_b128 v[28:31], v11 offset:5120
  s_waitcnt lgkmcnt(2)
  v_mfma_f32_16x16x32_bf16 v[40:43], v[172:175], v[32:35], v[40:43]
  v_mfma_f32_16x16x32_bf16 v[48:51], v[176:179], v[32:35], v[48:51]
  v_mfma_f32_16x16x32_bf16 v[56:59], v[180:183], v[32:35], v[56:59]
  ds_read_b128 v[32:35], v11 offset:6144
  v_mfma_f32_16x16x32_bf16 v[44:47], v[172:175], v[36:39], v[44:47]
  v_mfma_f32_16x16x32_bf16 v[52:55], v[176:179], v[36:39], v[52:55]
  v_mfma_f32_16x16x32_bf16 v[60:63], v[180:183], v[36:39], v[60:63]
  ds_read_b128 v[36:39], v11 offset:7168
  s_waitcnt lgkmcnt(2)
  v_mfma_f32_16x16x32_bf16 v[40:43], v[184:187], v[24:27], v[40:43]
  v_mfma_f32_16x16x32_bf16 v[48:51], v[188:191], v[24:27], v[48:51]
  v_mfma_f32_16x16x32_bf16 v[56:59], v[192:195], v[24:27], v[56:59]
  v_add_u32 v11, s67, v7
  ds_read_b128 v[24:27], v11 offset:0
  v_mfma_f32_16x16x32_bf16 v[44:47], v[184:187], v[28:31], v[44:47]
  v_mfma_f32_16x16x32_bf16 v[52:55], v[188:191], v[28:31], v[52:55]
  v_mfma_f32_16x16x32_bf16 v[60:63], v[192:195], v[28:31], v[60:63]
  ds_read_b128 v[28:31], v11 offset:1024
  s_waitcnt lgkmcnt(2)
  v_mfma_f32_16x16x32_bf16 v[40:43], v[196:199], v[32:35], v[40:43]
  v_mfma_f32_16x16x32_bf16 v[48:51], v[200:203], v[32:35], v[48:51]
  v_mfma_f32_16x16x32_bf16 v[56:59], v[204:207], v[32:35], v[56:59]
  ds_read_b128 v[32:35], v11 offset:2048
  v_mfma_f32_16x16x32_bf16 v[44:47], v[196:199], v[36:39], v[44:47]
  v_mfma_f32_16x16x32_bf16 v[52:55], v[200:203], v[36:39], v[52:55]
  v_mfma_f32_16x16x32_bf16 v[60:63], v[204:207], v[36:39], v[60:63]
  ds_read_b128 v[36:39], v11 offset:3072
  s_waitcnt lgkmcnt(2)
  v_mfma_f32_16x16x32_bf16 v[40:43], v[208:211], v[24:27], v[40:43]
  v_mfma_f32_16x16x32_bf16 v[48:51], v[212:215], v[24:27], v[48:51]
  v_mfma_f32_16x16x32_bf16 v[56:59], v[216:219], v[24:27], v[56:59]
  ds_read_b128 v[24:27], v11 offset:4096
  v_mfma_f32_16x16x32_bf16 v[44:47], v[208:211], v[28:31], v[44:47]
  v_mfma_f32_16x16x32_bf16 v[52:55], v[212:215], v[28:31], v[52:55]
  v_mfma_f32_16x16x32_bf16 v[60:63], v[216:219], v[28:31], v[60:63]
  ds_read_b128 v[28:31], v11 offset:5120
  s_waitcnt lgkmcnt(2)
  v_mfma_f32_16x16x32_bf16 v[40:43], v[220:223], v[32:35], v[40:43]
  v_mfma_f32_16x16x32_bf16 v[48:51], v[224:227], v[32:35], v[48:51]
  v_mfma_f32_16x16x32_bf16 v[56:59], v[228:231], v[32:35], v[56:59]
  ds_read_b128 v[32:35], v11 offset:6144
  v_mfma_f32_16x16x32_bf16 v[44:47], v[220:223], v[36:39], v[44:47]
  v_mfma_f32_16x16x32_bf16 v[52:55], v[224:227], v[36:39], v[52:55]
  v_mfma_f32_16x16x32_bf16 v[60:63], v[228:231], v[36:39], v[60:63]
  ds_read_b128 v[36:39], v11 offset:7168
  s_waitcnt lgkmcnt(3)
  v_mfma_f32_16x16x32_bf16 v[56:59], v[240:243], v[24:27], v[56:59]
  s_waitcnt lgkmcnt(2)
  v_mfma_f32_16x16x32_bf16 v[60:63], v[240:243], v[28:31], v[60:63]
  s_waitcnt lgkmcnt(1)
  v_mfma_f32_16x16x32_bf16 v[56:59], v[252:255], v[32:35], v[56:59]
  s_waitcnt lgkmcnt(0)
  v_mfma_f32_16x16x32_bf16 v[60:63], v[252:255], v[36:39], v[60:63]
  s_mov_b64 exec, 1
  ds_add_u32 v3, v4 offset:56
  s_mov_b64 exec, -1
  v_mfma_f32_16x16x32_bf16 v[40:43], v[232:235], v[24:27], v[40:43]
  v_mfma_f32_16x16x32_bf16 v[48:51], v[236:239], v[24:27], v[48:51]
  v_mfma_f32_16x16x32_bf16 v[44:47], v[232:235], v[28:31], v[44:47]
  v_mfma_f32_16x16x32_bf16 v[52:55], v[236:239], v[28:31], v[52:55]
  s_cmp_lg_u32 s15, 3
  s_cbranch_scc1 SXW_240
  s_mov_b64 exec, 0xffff
  ds_write2_b32 v10, v56, v60 offset0:64 offset1:80
  s_mov_b64 exec, -1
SXW_240:
  v_mfma_f32_16x16x32_bf16 v[40:43], v[244:247], v[32:35], v[40:43]
  v_mfma_f32_16x16x32_bf16 v[48:51], v[248:251], v[32:35], v[48:51]
  v_mfma_f32_16x16x32_bf16 v[44:47], v[244:247], v[36:39], v[44:47]
  v_mfma_f32_16x16x32_bf16 v[52:55], v[248:251], v[36:39], v[52:55]
  ds_read_b128 v[28:31], v2 offset:0
  ds_read_b128 v[32:35], v2 offset:16
  ds_read_b128 v[36:39], v2 offset:32
  ds_read2_b32 v[24:25], v10 offset0:64 offset1:80
  s_waitcnt lgkmcnt(0)
SK_242:
  v_max_u32 v26, v24, v25
  v_cmp_eq_u32 vcc, -1, v26
  s_cbranch_vccnz SC_241
SD_243:
  v_fma_f32 v56, v24, v36, v56
  v_fma_f32 v57, v24, v37, v57
  v_fma_f32 v58, v24, v38, v58
  v_fma_f32 v59, v24, v39, v59
  v_fma_f32 v60, v25, v36, v60
  v_fma_f32 v61, v25, v37, v61
  v_fma_f32 v62, v25, v38, v62
  v_fma_f32 v63, v25, v39, v63
  v_cvt_pk_bf16_f32 v56, v56, v57
  v_cvt_pk_bf16_f32 v57, v58, v59
  v_cvt_pk_bf16_f32 v58, v60, v61
  v_cvt_pk_bf16_f32 v59, v62, v63
  v_pk_max_i16 v56, v56, 0
  v_pk_max_i16 v57, v57, 0
  v_pk_max_i16 v58, v58, 0
  v_pk_max_i16 v59, v59, 0
  s_nop 0
  v_permlane16_swap_b32 v56, v58
  v_permlane16_swap_b32 v57, v59
  s_add_u32 s12, s29, 0
  s_cmp_eq_u32 s28, 32
  s_cbranch_scc0 LC_244
  buffer_store_dwordx4 v[56:59], v7, s[40:43], s12 offen
LD_245:
  v_fma_f32 v40, v24, v28, v40
  v_fma_f32 v41, v24, v29, v41
  v_fma_f32 v42, v24, v30, v42
  v_fma_f32 v43, v24, v31, v43
  v_fma_f32 v44, v25, v28, v44
  v_fma_f32 v45, v25, v29, v45
  v_fma_f32 v46, v25, v30, v46
  v_fma_f32 v47, v25, v31, v47
  v_cvt_pk_bf16_f32 v40, v40, v41
  v_cvt_pk_bf16_f32 v41, v42, v43
  v_cvt_pk_bf16_f32 v42, v44, v45
  v_cvt_pk_bf16_f32 v43, v46, v47
  v_pk_max_i16 v40, v40, 0
  v_pk_max_i16 v41, v41, 0
  v_pk_max_i16 v42, v42, 0
  v_pk_max_i16 v43, v43, 0
  s_nop 0
  v_permlane16_swap_b32 v40, v42
  v_permlane16_swap_b32 v41, v43
  s_add_u32 s12, s26, 0
  s_cmp_eq_u32 s28, 32
  s_cbranch_scc0 LC_246
  buffer_store_dwordx4 v[40:43], v7, s[40:43], s12 offen
LD_247:
  v_fma_f32 v48, v24, v32, v48
  v_fma_f32 v49, v24, v33, v49
  v_fma_f32 v50, v24, v34, v50
  v_fma_f32 v51, v24, v35, v51
  v_fma_f32 v52, v25, v32, v52
  v_fma_f32 v53, v25, v33, v53
  v_fma_f32 v54, v25, v34, v54
  v_fma_f32 v55, v25, v35, v55
  v_cvt_pk_bf16_f32 v48, v48, v49
  v_cvt_pk_bf16_f32 v49, v50, v51
  v_cvt_pk_bf16_f32 v50, v52, v53
  v_cvt_pk_bf16_f32 v51, v54, v55
  v_pk_max_i16 v48, v48, 0
  v_pk_max_i16 v49, v49, 0
  v_pk_max_i16 v50, v50, 0
  v_pk_max_i16 v51, v51, 0
  s_nop 0
  v_permlane16_swap_b32 v48, v50
  v_permlane16_swap_b32 v49, v51
  s_add_u32 s12, s57, 0
  s_cmp_eq_u32 s28, 32
  s_cbranch_scc0 LC_248
  buffer_store_dwordx4 v[48:51], v7, s[40:43], s12 offen
LD_249:
  s_setprio 2
  v_add_u32 v11, s64, v7
  s_mov_b32 s60, 1
  ds_read_b32 v1, v3 offset:44
  s_waitcnt lgkmcnt(0)
  v_cmp_gt_u32 vcc, 4, v1
  s_cbranch_vccz XW_250
  s_waitcnt vmcnt(0)
  s_add_u32 s11, s18, 49152
  s_mov_b64 exec, 1
  s_cmp_eq_u32 s28, 32
  s_cbranch_scc0 LC_251
  buffer_store_dword v5, off, s[40:43], s11
LD_252:
  s_mov_b64 exec, -1
  s_mov_b32 s60, 0
  ds_read_b32 v1, v3 offset:44
  s_waitcnt lgkmcnt(0)
SK_254:
  v_cmp_gt_u32 vcc, 4, v1
  s_cbranch_vccnz SC_253
SD_255:
XW_250:
  ds_read_b128 v[24:27], v11 offset:32768
  ds_read_b128 v[28:31], v11 offset:33792
  ds_read_b128 v[32:35], v11 offset:34816
  ds_read_b128 v[36:39], v11 offset:35840
  s_waitcnt lgkmcnt(2)
  v_mfma_f32_16x16x32_bf16 v[40:43], v[64:67], v[24:27], 0
  v_mfma_f32_16x16x32_bf16 v[48:51], v[68:71], v[24:27], 0
  v_mfma_f32_16x16x32_bf16 v[56:59], v[72:75], v[24:27], 0
  ds_read_b128 v[24:27], v11 offset:36864
  v_mfma_f32_16x16x32_bf16 v[44:47], v[64:67], v[28:31], 0
  v_mfma_f32_16x16x32_bf16 v[52:55], v[68:71], v[28:31], 0
  v_mfma_f32_16x16x32_bf16 v[60:63], v[72:75], v[28:31], 0
  s_cmp_eq_u32 s60, 1
  s_cbranch_scc0 HF_256
  s_waitcnt vmcnt(0)
  s_add_u32 s11, s18, 49152
  s_mov_b64 exec, 1
  s_cmp_eq_u32 s28, 32
  s_cbranch_scc0 LC_257
  buffer_store_dword v5, off, s[40:43], s11
LD_258:
  s_mov_b64 exec, -1
HF_256:
  ds_read_b128 v[28:31], v11 offset:37888
  s_waitcnt lgkmcnt(2)
  v_mfma_f32_16x16x32_bf16 v[40:43], v[76:79], v[32:35], v[40:43]
  v_mfma_f32_16x16x32_bf16 v[48:51], v[80:83], v[32:35], v[48:51]
  v_mfma_f32_16x16x32_bf16 v[56:59], v[84:87], v[32:35], v[56:59]
  ds_read_b128 v[32:35], v11 offset:38912
  v_mfma_f32_16x16x32_bf16 v[44:47], v[76:79], v[36:39], v[44:47]
  v_mfma_f32_16x16x32_bf16 v[52:55], v[80:83], v[36:39], v[52:55]
  v_mfma_f32_16x16x32_bf16 v[60:63], v[84:87], v[36:39], v[60:63]
  ds_read_b128 v[36:39], v11 offset:39936
  s_waitcnt lgkmcnt(2)
  v_mfma_f32_16x16x32_bf16 v[40:43], v[88:91], v[24:27], v[40:43]
  v_mfma_f32_16x16x32_bf16 v[48:51], v[92:95], v[24:27], v[48:51]
  v_mfma_f32_16x16x32_bf16 v[56:59], v[96:99], v[24:27], v[56:59]
  v_add_u32 v11, s65, v7
  ds_read_b128 v[24:27], v11 offset:32768
  v_mfma_f32_16x16x32_bf16 v[44:47], v[88:91], v[28:31], v[44:47]
  v_mfma_f32_16x16x32_bf16 v[52:55], v[92:95], v[28:31], v[52:55]
  v_mfma_f32_16x16x32_bf16 v[60:63], v[96:99], v[28:31], v[60:63]
  ds_read_b128 v[28:31], v11 offset:33792
  s_waitcnt lgkmcnt(2)
  v_mfma_f32_16x16x32_bf16 v[40:43], v[100:103], v[32:35], v[40:43]
  v_mfma_f32_16x16x32_bf16 v[48:51], v[104:107], v[32:35], v[48:51]
  v_mfma_f32_16x16x32_bf16 v[56:59], v[108:111], v[32:35], v[56:59]
  ds_read_b128 v[32:35], v11 offset:34816
  v_mfma_f32_16x16x32_bf16 v[44:47], v[100:103], v[36:39], v[44:47]
  v_mfma_f32_16x16x32_bf16 v[52:55], v[104:107], v[36:39], v[52:55]
  v_mfma_f32_16x16x32_bf16 v[60:63], v[108:111], v[36:39], v[60:63]
  ds_read_b128 v[36:39], v11 offset:35840
  s_waitcnt lgkmcnt(2)
  v_mfma_f32_16x16x32_bf16 v[40:43], v[112:115], v[24:27], v[40:43]
  v_mfma_f32_16x16x32_bf16 v[48:51], v[116:119], v[24:27], v[48:51]
  v_mfma_f32_16x16x32_bf16 v[56:59], v[120:123], v[24:27], v[56:59]
  ds_read_b128 v[24:27], v11 offset:36864
  v_mfma_f32_16x16x32_bf16 v[44:47], v[112:115], v[28:31], v[44:47]
  v_mfma_f32_16x16x32_bf16 v[52:55], v[116:119], v[28:31], v[52:55]
  v_mfma_f32_16x16x32_bf16 v[60:63], v[120:123], v[28:31], v[60:63]
  ds_read_b128 v[28:31], v11 offset:37888
  s_waitcnt lgkmcnt(2)
  v_mfma_f32_16x16x32_bf16 v[40:43], v[124:127], v[32:35], v[40:43]
  v_mfma_f32_16x16x32_bf16 v[48:51], v[128:131], v[32:35], v[48:51]
  v_mfma_f32_16x16x32_bf16 v[56:59], v[132:135], v[32:35], v[56:59]
  ds_read_b128 v[32:35], v11 offset:38912
  v_mfma_f32_16x16x32_bf16 v[44:47], v[124:127], v[36:39], v[44:47]
  v_mfma_f32_16x16x32_bf16 v[52:55], v[128:131], v[36:39], v[52:55]
  v_mfma_f32_16x16x32_bf16 v[60:63], v[132:135], v[36:39], v[60:63]
  ds_read_b128 v[36:39], v11 offset:39936
  s_waitcnt lgkmcnt(2)
  v_mfma_f32_16x16x32_bf16 v[40:43], v[136:139], v[24:27], v[40:43]
  v_mfma_f32_16x16x32_bf16 v[48:51], v[140:143], v[24:27], v[48:51]
  v_mfma_f32_16x16x32_bf16 v[56:59], v[144:147], v[24:27], v[56:59]
  v_add_u32 v11, s66, v7
  ds_read_b128 v[24:27], v11 offset:32768
  v_mfma_f32_16x16x32_bf16 v[44:47], v[136:139], v[28:31], v[44:47]
  v_mfma_f32_16x16x32_bf16 v[52:55], v[140:143], v[28:31], v[52:55]
  v_mfma_f32_16x16x32_bf16 v[60:63], v[144:147], v[28:31], v[60:63]
  ds_read_b128 v[28:31], v11 offset:33792
  s_waitcnt lgkmcnt(2)
  v_mfma_f32_16x16x32_bf16 v[40:43], v[148:151], v[32:35], v[40:43]
  v_mfma_f32_16x16x32_bf16 v[48:51], v[152:155], v[32:35], v[48:51]
  v_mfma_f32_16x16x32_bf16 v[56:59], v[156:159], v[32:35], v[56:59]
  ds_read_b128 v[32:35], v11 offset:34816
  v_mfma_f32_16x16x32_bf16 v[44:47], v[148:151], v[36:39], v[44:47]
  v_mfma_f32_16x16x32_bf16 v[52:55], v[152:155], v[36:39], v[52:55]
  v_mfma_f32_16x16x32_bf16 v[60:63], v[156:159], v[36:39], v[60:63]
  ds_read_b128 v[36:39], v11 offset:35840
  s_waitcnt lgkmcnt(2)
  v_mfma_f32_16x16x32_bf16 v[40:43], v[160:163], v[24:27], v[40:43]
  v_mfma_f32_16x16x32_bf16 v[48:51], v[164:167], v[24:27], v[48:51]
  v_mfma_f32_16x16x32_bf16 v[56:59], v[168:171], v[24:27], v[56:59]
  ds_read_b128 v[24:27], v11 offset:36864
  v_mfma_f32_16x16x32_bf16 v[44:47], v[160:163], v[28:31], v[44:47]
  v_mfma_f32_16x16x32_bf16 v[52:55], v[164:167], v[28:31], v[52:55]
  v_mfma_f32_16x16x32_bf16 v[60:63], v[168:171], v[28:31], v[60:63]
  ds_read_b128 v[28:31], v11 offset:37888
  s_waitcnt lgkmcnt(2)
  v_mfma_f32_16x16x32_bf16 v[40:43], v[172:175], v[32:35], v[40:43]
  v_mfma_f32_16x16x32_bf16 v[48:51], v[176:179], v[32:35], v[48:51]
  v_mfma_f32_16x16x32_bf16 v[56:59], v[180:183], v[32:35], v[56:59]
  ds_read_b128 v[32:35], v11 offset:38912
  v_mfma_f32_16x16x32_bf16 v[44:47], v[172:175], v[36:39], v[44:47]
  v_mfma_f32_16x16x32_bf16 v[52:55], v[176:179], v[36:39], v[52:55]
  v_mfma_f32_16x16x32_bf16 v[60:63], v[180:183], v[36:39], v[60:63]
  ds_read_b128 v[36:39], v11 offset:39936
  s_waitcnt lgkmcnt(2)
  v_mfma_f32_16x16x32_bf16 v[40:43], v[184:187], v[24:27], v[40:43]
  v_mfma_f32_16x16x32_bf16 v[48:51], v[188:191], v[24:27], v[48:51]
  v_mfma_f32_16x16x32_bf16 v[56:59], v[192:195], v[24:27], v[56:59]
  v_add_u32 v11, s67, v7
  ds_read_b128 v[24:27], v11 offset:32768
  v_mfma_f32_16x16x32_bf16 v[44:47], v[184:187], v[28:31], v[44:47]
  v_mfma_f32_16x16x32_bf16 v[52:55], v[188:191], v[28:31], v[52:55]
  v_mfma_f32_16x16x32_bf16 v[60:63], v[192:195], v[28:31], v[60:63]
  ds_read_b128 v[28:31], v11 offset:33792
  s_waitcnt lgkmcnt(2)
  v_mfma_f32_16x16x32_bf16 v[40:43], v[196:199], v[32:35], v[40:43]
  v_mfma_f32_16x16x32_bf16 v[48:51], v[200:203], v[32:35], v[48:51]
  v_mfma_f32_16x16x32_bf16 v[56:59], v[204:207], v[32:35], v[56:59]
  ds_read_b128 v[32:35], v11 offset:34816
  v_mfma_f32_16x16x32_bf16 v[44:47], v[196:199], v[36:39], v[44:47]
  v_mfma_f32_16x16x32_bf16 v[52:55], v[200:203], v[36:39], v[52:55]
  v_mfma_f32_16x16x32_bf16 v[60:63], v[204:207], v[36:39], v[60:63]
  ds_read_b128 v[36:39], v11 offset:35840
  s_waitcnt lgkmcnt(2)
  v_mfma_f32_16x16x32_bf16 v[40:43], v[208:211], v[24:27], v[40:43]
  v_mfma_f32_16x16x32_bf16 v[48:51], v[212:215], v[24:27], v[48:51]
  v_mfma_f32_16x16x32_bf16 v[56:59], v[216:219], v[24:27], v[56:59]
  ds_read_b128 v[24:27], v11 offset:36864
  v_mfma_f32_16x16x32_bf16 v[44:47], v[208:211], v[28:31], v[44:47]
  v_mfma_f32_16x16x32_bf16 v[52:55], v[212:215], v[28:31], v[52:55]
  v_mfma_f32_16x16x32_bf16 v[60:63], v[216:219], v[28:31], v[60:63]
  ds_read_b128 v[28:31], v11 offset:37888
  s_waitcnt lgkmcnt(2)
  v_mfma_f32_16x16x32_bf16 v[40:43], v[220:223], v[32:35], v[40:43]
  v_mfma_f32_16x16x32_bf16 v[48:51], v[224:227], v[32:35], v[48:51]
  v_mfma_f32_16x16x32_bf16 v[56:59], v[228:231], v[32:35], v[56:59]
  ds_read_b128 v[32:35], v11 offset:38912
  v_mfma_f32_16x16x32_bf16 v[44:47], v[220:223], v[36:39], v[44:47]
  v_mfma_f32_16x16x32_bf16 v[52:55], v[224:227], v[36:39], v[52:55]
  v_mfma_f32_16x16x32_bf16 v[60:63], v[228:231], v[36:39], v[60:63]
  ds_read_b128 v[36:39], v11 offset:39936
  s_waitcnt lgkmcnt(3)
  v_mfma_f32_16x16x32_bf16 v[56:59], v[240:243], v[24:27], v[56:59]
  s_waitcnt lgkmcnt(2)
  v_mfma_f32_16x16x32_bf16 v[60:63], v[240:243], v[28:31], v[60:63]
  s_waitcnt lgkmcnt(1)
  v_mfma_f32_16x16x32_bf16 v[56:59], v[252:255], v[32:35], v[56:59]
  s_waitcnt lgkmcnt(0)
  v_mfma_f32_16x16x32_bf16 v[60:63], v[252:255], v[36:39], v[60:63]
  s_mov_b64 exec, 1
  ds_add_u32 v3, v4 offset:60
  s_mov_b64 exec, -1
  v_mfma_f32_16x16x32_bf16 v[40:43], v[232:235], v[24:27], v[40:43]
  v_mfma_f32_16x16x32_bf16 v[48:51], v[236:239], v[24:27], v[48:51]
  v_mfma_f32_16x16x32_bf16 v[44:47], v[232:235], v[28:31], v[44:47]
  v_mfma_f32_16x16x32_bf16 v[52:55], v[236:239], v[28:31], v[52:55]
  s_cmp_lg_u32 s15, 3
  s_cbranch_scc1 SXW_259
  s_mov_b64 exec, 0xffff
  ds_write2_b32 v10, v56, v60 offset0:96 offset1:112
  s_mov_b64 exec, -1
SXW_259:
  v_mfma_f32_16x16x32_bf16 v[40:43], v[244:247], v[32:35], v[40:43]
  v_mfma_f32_16x16x32_bf16 v[48:51], v[248:251], v[32:35], v[48:51]
  v_mfma_f32_16x16x32_bf16 v[44:47], v[244:247], v[36:39], v[44:47]
  v_mfma_f32_16x16x32_bf16 v[52:55], v[248:251], v[36:39], v[52:55]
  ds_read_b128 v[28:31], v2 offset:0
  ds_read_b128 v[32:35], v2 offset:16
  ds_read_b128 v[36:39], v2 offset:32
  ds_read2_b32 v[24:25], v10 offset0:96 offset1:112
  s_waitcnt lgkmcnt(0)
SK_261:
  v_max_u32 v26, v24, v25
  v_cmp_eq_u32 vcc, -1, v26
  s_cbranch_vccnz SC_260
SD_262:
  v_fma_f32 v56, v24, v36, v56
  v_fma_f32 v57, v24, v37, v57
  v_fma_f32 v58, v24, v38, v58
  v_fma_f32 v59, v24, v39, v59
  v_fma_f32 v60, v25, v36, v60
  v_fma_f32 v61, v25, v37, v61
  v_fma_f32 v62, v25, v38, v62
  v_fma_f32 v63, v25, v39, v63
  v_cvt_pk_bf16_f32 v56, v56, v57
  v_cvt_pk_bf16_f32 v57, v58, v59
  v_cvt_pk_bf16_f32 v58, v60, v61
  v_cvt_pk_bf16_f32 v59, v62, v63
  v_pk_max_i16 v56, v56, 0
  v_pk_max_i16 v57, v57, 0
  v_pk_max_i16 v58, v58, 0
  v_pk_max_i16 v59, v59, 0
  s_nop 0
  v_permlane16_swap_b32 v56, v58
  v_permlane16_swap_b32 v57, v59
  s_add_u32 s12, s29, 2883584
  s_cmp_eq_u32 s28, 32
  s_cbranch_scc0 LC_263
  buffer_store_dwordx4 v[56:59], v7, s[40:43], s12 offen
LD_264:
  v_fma_f32 v40, v24, v28, v40
  v_fma_f32 v41, v24, v29, v41
  v_fma_f32 v42, v24, v30, v42
  v_fma_f32 v43, v24, v31, v43
  v_fma_f32 v44, v25, v28, v44
  v_fma_f32 v45, v25, v29, v45
  v_fma_f32 v46, v25, v30, v46
  v_fma_f32 v47, v25, v31, v47
  v_cvt_pk_bf16_f32 v40, v40, v41
  v_cvt_pk_bf16_f32 v41, v42, v43
  v_cvt_pk_bf16_f32 v42, v44, v45
  v_cvt_pk_bf16_f32 v43, v46, v47
  v_pk_max_i16 v40, v40, 0
  v_pk_max_i16 v41, v41, 0
  v_pk_max_i16 v42, v42, 0
  v_pk_max_i16 v43, v43, 0
  s_nop 0
  v_permlane16_swap_b32 v40, v42
  v_permlane16_swap_b32 v41, v43
  s_add_u32 s12, s26, 2883584
  s_cmp_eq_u32 s28, 32
  s_cbranch_scc0 LC_265
  buffer_store_dwordx4 v[40:43], v7, s[40:43], s12 offen
LD_266:
  v_fma_f32 v48, v24, v32, v48
  v_fma_f32 v49, v24, v33, v49
  v_fma_f32 v50, v24, v34, v50
  v_fma_f32 v51, v24, v35, v51
  v_fma_f32 v52, v25, v32, v52
  v_fma_f32 v53, v25, v33, v53
  v_fma_f32 v54, v25, v34, v54
  v_fma_f32 v55, v25, v35, v55
  v_cvt_pk_bf16_f32 v48, v48, v49
  v_cvt_pk_bf16_f32 v49, v50, v51
  v_cvt_pk_bf16_f32 v50, v52, v53
  v_cvt_pk_bf16_f32 v51, v54, v55
  v_pk_max_i16 v48, v48, 0
  v_pk_max_i16 v49, v49, 0
  v_pk_max_i16 v50, v50, 0
  v_pk_max_i16 v51, v51, 0
  s_nop 0
  v_permlane16_swap_b32 v48, v50
  v_permlane16_swap_b32 v49, v51
  s_add_u32 s12, s57, 2883584
  s_cmp_eq_u32 s28, 32
  s_cbranch_scc0 LC_267
  buffer_store_dwordx4 v[48:51], v7, s[40:43], s12 offen
LD_268:
  s_add_u32 s13, s23, 262144
  buffer_load_dwordx4 v[24:27], v7, s[40:43], s13 offen sc1
  s_waitcnt vmcnt(0)
  s_add_u32 s11, s18, 65536
  s_mov_b64 exec, 1
  s_cmp_eq_u32 s28, 32
  s_cbranch_scc0 LC_269
  buffer_store_dword v5, off, s[40:43], s11
LD_270:
  s_mov_b64 exec, -1
SK_272:
  v_xor_b32 v25, v5, v25
  v_xor_b32 v27, v5, v27
  v_xor_b32 v25, 2, v25
  v_xor_b32 v27, 2, v27
  v_or_b32 v25, v25, v27
  v_cmp_ne_u32 vcc, 0, v25
  s_cbranch_vccnz SC_271
SD_273:
  v_add_f32 v24, v24, v24 row_ror:8
  v_add_f32 v26, v26, v26 row_ror:8
  s_nop 1
  v_permlane16_swap_b32 v24, v26
  v_add_f32 v24, v24, v26
  v_mov_b32 v27, v24
  s_nop 1
  v_permlane32_swap_b32 v24, v27
  v_add_f32 v24, v24, v27
  v_mov_b32 v26, v24
  s_nop 1
  v_permlane16_swap_b32 v24, v26
  v_mul_f32 v24, s61, v24
  v_mul_f32 v26, s61, v26
  v_fma_f32 v26, -v24, v24, v26
  v_max_f32 v26, 0, v26
  v_add_f32 v26, s62, v26
  v_rsq_f32 v6, v26
  s_setprio 3
  v_xor_b32 v25, 128, v20
  ds_read_b32 v24, v3 offset:72
  s_waitcnt lgkmcnt(0)
SK_275:
  v_cmp_gt_u32 vcc, 4, v24
  s_cbranch_vccnz SC_274
SD_276:
  ds_read_b128 v[32:35], v20 offset:0
  ds_read_b128 v[36:39], v25 offset:0
  ds_read_b128 v[40:43], v20 offset:8192
  ds_read_b128 v[44:47], v25 offset:8192
  ds_read_b128 v[48:51], v20 offset:16384
  ds_read_b128 v[52:55], v25 offset:16384
  ds_read_b128 v[56:59], v20 offset:24576
  ds_read_b128 v[60:63], v25 offset:24576
  s_waitcnt lgkmcnt(4)
  v_add_f32 v32, v32, v40
  v_add_f32 v33, v33, v41
  v_add_f32 v34, v34, v42
  v_add_f32 v35, v35, v43
  v_add_f32 v36, v36, v44
  v_add_f32 v37, v37, v45
  v_add_f32 v38, v38, v46
  v_add_f32 v39, v39, v47
  v_lshlrev_b32 v40, 16, v12
  v_and_b32 v41, 0xffff0000, v12
  v_lshlrev_b32 v42, 16, v13
  v_and_b32 v43, 0xffff0000, v13
  v_lshlrev_b32 v44, 16, v14
  v_and_b32 v45, 0xffff0000, v14
  v_lshlrev_b32 v46, 16, v15
  v_and_b32 v47, 0xffff0000, v15
  v_fma_f32 v40, v32, v6, v40
  v_fma_f32 v41, v33, v6, v41
  v_fma_f32 v42, v34, v6, v42
  v_fma_f32 v43, v35, v6, v43
  v_fma_f32 v44, v36, v6, v44
  v_fma_f32 v45, v37, v6, v45
  v_fma_f32 v46, v38, v6, v46
  v_fma_f32 v47, v39, v6, v47
  s_waitcnt lgkmcnt(0)
  v_add_f32 v48, v48, v56
  v_add_f32 v49, v49, v57
  v_add_f32 v50, v50, v58
  v_add_f32 v51, v51, v59
  v_add_f32 v52, v52, v60
  v_add_f32 v53, v53, v61
  v_add_f32 v54, v54, v62
  v_add_f32 v55, v55, v63
  v_fma_f32 v40, v48, v6, v40
  v_fma_f32 v41, v49, v6, v41
  v_fma_f32 v42, v50, v6, v42
  v_fma_f32 v43, v51, v6, v43
  v_fma_f32 v44, v52, v6, v44
  v_fma_f32 v45, v53, v6, v45
  v_fma_f32 v46, v54, v6, v46
  v_fma_f32 v47, v55, v6, v47
  v_cvt_pk_bf16_f32 v12, v40, v41
  v_cvt_pk_bf16_f32 v13, v42, v43
  v_cvt_pk_bf16_f32 v14, v44, v45
  v_cvt_pk_bf16_f32 v15, v46, v47
  ds_read_b32 v24, v3 offset:28
  s_waitcnt lgkmcnt(0)
SK_278:
  v_cmp_gt_u32 vcc, 8, v24
  s_cbranch_vccnz SC_277
SD_279:
  s_add_u32 s11, s25, 0
  buffer_store_dwordx4 v[12:15], v23, s[52:55], s11 offen sc1
L_FIN1:
  s_endpgm
SC_138:
  s_add_u32 s10, s10, 1
  s_cmp_gt_u32 s10, 0x20000
  s_cbranch_scc1 SD_140
  ds_read_b32 v1, v3 offset:28
  s_waitcnt lgkmcnt(0)
  s_branch SK_139
SC_142:
  s_add_u32 s10, s10, 1
  s_cmp_gt_u32 s10, 0x20000
  s_cbranch_scc1 SD_144
  ds_read_b32 v1, v3 offset:20
  s_waitcnt lgkmcnt(0)
  s_branch SK_143
SC_145:
  s_add_u32 s10, s10, 1
  s_cmp_gt_u32 s10, 0x20000
  s_cbranch_scc1 SD_147
  ds_read_b32 v1, v3 offset:88
  s_waitcnt lgkmcnt(0)
  s_branch SK_146
SC_148:
  s_add_u32 s10, s10, 1
  s_cmp_gt_u32 s10, 0x20000
  s_cbranch_scc1 SD_150
  ds_read_b32 v1, v3 offset:88
  s_waitcnt lgkmcnt(0)
  s_branch SK_149
SC_151:
  s_add_u32 s10, s10, 1
  s_cmp_gt_u32 s10, 0x20000
  s_cbranch_scc1 SD_153
  ds_read_b32 v1, v3 offset:88
  s_waitcnt lgkmcnt(0)
  s_branch SK_152
SC_154:
  s_add_u32 s10, s10, 1
  s_cmp_gt_u32 s10, 0x20000
  s_cbranch_scc1 SD_156
  ds_read_b32 v1, v3 offset:88
  s_waitcnt lgkmcnt(0)
  s_branch SK_155
SC_157:
  s_add_u32 s10, s10, 1
  s_cmp_gt_u32 s10, 0x20000
  s_cbranch_scc1 SD_159
  ds_read_b32 v1, v3 offset:88
  s_waitcnt lgkmcnt(0)
  s_branch SK_158
SC_160:
  s_add_u32 s10, s10, 1
  s_cmp_gt_u32 s10, 0x20000
  s_cbranch_scc1 SD_162
  ds_read_b32 v1, v3 offset:88
  s_waitcnt lgkmcnt(0)
  s_branch SK_161
SC_163:
  s_add_u32 s10, s10, 1
  s_cmp_gt_u32 s10, 0x20000
  s_cbranch_scc1 SD_165
  ds_read_b32 v1, v3 offset:88
  s_waitcnt lgkmcnt(0)
  s_branch SK_164
SC_166:
  s_add_u32 s10, s10, 1
  s_cmp_gt_u32 s10, 0x20000
  s_cbranch_scc1 SD_168
  ds_read_b32 v1, v3 offset:88
  s_waitcnt lgkmcnt(0)
  s_branch SK_167
MC_169:
  s_mov_b32 s28, 0
  s_branch MD_171
SC_180:
  s_add_u32 s10, s10, 1
  s_cmp_gt_u32 s10, 0x20000
  s_cbranch_scc1 SD_182
  ds_read_b32 v1, v3 offset:32
  s_waitcnt lgkmcnt(0)
  s_branch SK_181
SC_184:
  s_add_u32 s10, s10, 1
  s_cmp_gt_u32 s10, 0x20000
  s_cbranch_scc1 SD_186
  ds_read2_b32 v[24:25], v10 offset0:0 offset1:16
  s_waitcnt lgkmcnt(0)
  s_branch SK_185
LC_187:
  buffer_store_dwordx4 v[56:59], v7, s[40:43], s12 offen sc1
  s_branch LD_188
LC_189:
  buffer_store_dwordx4 v[40:43], v7, s[40:43], s12 offen sc1
  s_branch LD_190
LC_191:
  buffer_store_dwordx4 v[48:51], v7, s[40:43], s12 offen sc1
  s_branch LD_192
LC_194:
  buffer_store_dword v5, off, s[40:43], s11 sc1
  s_branch LD_195
SC_196:
  s_add_u32 s10, s10, 1
  s_cmp_gt_u32 s10, 0x20000
  s_cbranch_scc1 SD_198
  ds_read_b32 v1, v3 offset:36
  s_waitcnt lgkmcnt(0)
  s_branch SK_197
LC_200:
  buffer_store_dword v5, off, s[40:43], s11 sc1
  s_branch LD_201
SC_203:
  s_add_u32 s10, s10, 1
  s_cmp_gt_u32 s10, 0x20000
  s_cbranch_scc1 SD_205
  ds_read2_b32 v[24:25], v10 offset0:32 offset1:48
  s_waitcnt lgkmcnt(0)
  s_branch SK_204
LC_206:
  buffer_store_dwordx4 v[56:59], v7, s[40:43], s12 offen sc1
  s_branch LD_207
LC_208:
  buffer_store_dwordx4 v[40:43], v7, s[40:43], s12 offen sc1
  s_branch LD_209
LC_210:
  buffer_store_dwordx4 v[48:51], v7, s[40:43], s12 offen sc1
  s_branch LD_211
LC_212:
  buffer_store_dword v5, off, s[40:43], s11 sc1
  s_branch LD_213
SC_214:
  s_add_u32 s10, s10, 1
  s_cmp_gt_u32 s10, 0x20000
  s_cbranch_scc1 SD_216
  s_add_u32 s13, s23, 262144
  buffer_load_dwordx4 v[24:27], v7, s[40:43], s13 offen sc1
  s_waitcnt vmcnt(0)
  s_branch SK_215
SC_217:
  s_add_u32 s10, s10, 1
  s_cmp_gt_u32 s10, 0x20000
  s_cbranch_scc1 SD_219
  ds_read_b32 v24, v3 offset:64
  s_waitcnt lgkmcnt(0)
  s_branch SK_218
LC_220:
  buffer_store_dwordx2 v[24:25], v21, s[40:43], s11 offen sc1
  s_branch LD_221
SC_222:
  s_add_u32 s10, s10, 1
  s_cmp_gt_u32 s10, 0x20000
  s_cbranch_scc1 SD_224
  s_add_u32 s13, s23, 0
  buffer_load_dwordx4 v[24:27], v7, s[40:43], s13 offen sc1
  s_waitcnt vmcnt(0)
  s_branch SK_223
LC_225:
  buffer_store_dwordx4 v[12:15], v22, s[40:43], s11 offen sc1
  s_branch LD_226
LC_227:
  buffer_store_dwordx2 v[24:25], v21, s[40:43], s11 offen sc1
  s_branch LD_228
LC_229:
  buffer_store_dword v5, off, s[40:43], s11 sc1
  s_branch LD_230
SC_231:
  s_add_u32 s10, s10, 1
  s_cmp_gt_u32 s10, 0x20000
  s_cbranch_scc1 SD_233
  ds_read_b32 v30, v3 offset:80
  s_waitcnt lgkmcnt(0)
  s_branch SK_232
SC_234:
  s_add_u32 s10, s10, 1
  s_cmp_gt_u32 s10, 0x20000
  s_cbranch_scc1 SD_236
  buffer_load_dword v28, v8, s[40:43], s14 offen sc1
  s_waitcnt vmcnt(0)
  s_branch SK_235
SC_237:
  s_add_u32 s10, s10, 1
  s_cmp_gt_u32 s10, 0x20000
  s_cbranch_scc1 SD_239
  ds_read_b32 v1, v3 offset:40
  s_waitcnt lgkmcnt(0)
  s_branch SK_238
SC_241:
  s_add_u32 s10, s10, 1
  s_cmp_gt_u32 s10, 0x20000
  s_cbranch_scc1 SD_243
  ds_read2_b32 v[24:25], v10 offset0:64 offset1:80
  s_waitcnt lgkmcnt(0)
  s_branch SK_242
LC_244:
  buffer_store_dwordx4 v[56:59], v7, s[40:43], s12 offen sc1
  s_branch LD_245
LC_246:
  buffer_store_dwordx4 v[40:43], v7, s[40:43], s12 offen sc1
  s_branch LD_247
LC_248:
  buffer_store_dwordx4 v[48:51], v7, s[40:43], s12 offen sc1
  s_branch LD_249
LC_251:
  buffer_store_dword v5, off, s[40:43], s11 sc1
  s_branch LD_252
SC_253:
  s_add_u32 s10, s10, 1
  s_cmp_gt_u32 s10, 0x20000
  s_cbranch_scc1 SD_255
  ds_read_b32 v1, v3 offset:44
  s_waitcnt lgkmcnt(0)
  s_branch SK_254
LC_257:
  buffer_store_dword v5, off, s[40:43], s11 sc1
  s_branch LD_258
SC_260:
  s_add_u32 s10, s10, 1
  s_cmp_gt_u32 s10, 0x20000
  s_cbranch_scc1 SD_262
  ds_read2_b32 v[24:25], v10 offset0:96 offset1:112
  s_waitcnt lgkmcnt(0)
  s_branch SK_261
LC_263:
  buffer_store_dwordx4 v[56:59], v7, s[40:43], s12 offen sc1
  s_branch LD_264
LC_265:
  buffer_store_dwordx4 v[40:43], v7, s[40:43], s12 offen sc1
  s_branch LD_266
LC_267:
  buffer_store_dwordx4 v[48:51], v7, s[40:43], s12 offen sc1
  s_branch LD_268
LC_269:
  buffer_store_dword v5, off, s[40:43], s11 sc1
  s_branch LD_270
SC_271:
  s_add_u32 s10, s10, 1
  s_cmp_gt_u32 s10, 0x20000
  s_cbranch_scc1 SD_273
  s_add_u32 s13, s23, 262144
  buffer_load_dwordx4 v[24:27], v7, s[40:43], s13 offen sc1
  s_waitcnt vmcnt(0)
  s_branch SK_272
SC_274:
  s_add_u32 s10, s10, 1
  s_cmp_gt_u32 s10, 0x20000
  s_cbranch_scc1 SD_276
  ds_read_b32 v24, v3 offset:72
  s_waitcnt lgkmcnt(0)
  s_branch SK_275
SC_277:
  s_add_u32 s10, s10, 1
  s_cmp_gt_u32 s10, 0x20000
  s_cbranch_scc1 SD_279
  ds_read_b32 v24, v3 offset:28
  s_waitcnt lgkmcnt(0)
  s_branch SK_278
L_END:
  s_endpgm
L_CODE_END:
.section .rodata,"a"
.p2align 6
.amdhsa_kernel interleave_layers__ssm_conv_h3__dense_activation_relu__prompt_kernel
  .amdhsa_next_free_vgpr 256
  .amdhsa_next_free_sgpr 102
  .amdhsa_accum_offset 256
  .amdhsa_group_segment_fixed_size 0
  .amdhsa_kernarg_size 96
  .amdhsa_user_sgpr_count 2
  .amdhsa_user_sgpr_kernarg_segment_ptr 1
  .amdhsa_system_sgpr_workgroup_id_x 1
.end_amdhsa_kernel
```
